```python
import torch

def _softmax(x, axis=-1):
    return torch.softmax(x, dim=axis)
def _gelu(x):
    return torch.nn.functional.gelu(x, approximate="tanh")
def _silu(x):
    return torch.nn.functional.silu(x)
def _sigmoid(x):
    return torch.sigmoid(x)
def _layernorm(x, axis=-1, eps=1e-5):
    m = x.mean(dim=axis, keepdim=True)
    v = x.var(dim=axis, keepdim=True, unbiased=False)
    return (x - m) / torch.sqrt(v + eps)
def _scatter_add(tgt, idx, src, axis=0):
    return tgt.clone().index_add_(axis, idx, src)
def _segment_sum(src, seg, n):
    out = torch.zeros((n,) + src.shape[1:], dtype=src.dtype)
    return out.index_add_(0, seg, src)
def _pad(x, pw):
    flat = tuple(v for pair in reversed(pw) for v in pair)
    return torch.nn.functional.pad(x, flat)

kernel_name = 'concat_heads__gqa_block_cached__gqa_block_cached__near_ridge'

def setup_inputs():

    _w = (lambda a: (lambda t: t.to(torch.bfloat16) if t.is_floating_point() else t)(torch.as_tensor(a)))
    def _A_setup():
        B, Sq, D = 8, 96, 640
        Hq, Hkv, Sk, Dh = 32, 32, 96, 128
        assert Hq % Hkv == 0, (Hq, Hkv)
        return {
            "x": _w((lambda *s: torch.randn(*s, dtype=torch.bfloat16) * 0.8)(B, Sq, D)),
            "k_cache": _w((lambda *s: torch.randn(*s, dtype=torch.bfloat16) * 0.8)(B, Hkv, Sk, Dh)),
            "v_cache": _w((lambda *s: torch.randn(*s, dtype=torch.bfloat16) * 0.05)(B, Hkv, Sk, Dh)),
            "wq": _w((lambda *s: torch.randn(*s, dtype=torch.bfloat16) * 0.8)(D, Hq * Dh) * (D ** -0.5)),
            "wo": _w((lambda *s: torch.randn(*s, dtype=torch.bfloat16) * 0.05)(Hq * Dh, D) * ((Hq * Dh) ** -0.5)),
        }
    _A_in = _A_setup()

    def _B_setup():
        B, Sq, D = 8, 96, 640
        Hq, Hkv, Sk, Dh = 32, 32, 96, 128
        assert Hq % Hkv == 0, (Hq, Hkv)
        return {
            "x": _w((lambda *s: torch.randn(*s, dtype=torch.bfloat16) * 0.8)(B, Sq, D)),
            "k_cache": _w((lambda *s: torch.randn(*s, dtype=torch.bfloat16) * 0.8)(B, Hkv, Sk, Dh)),
            "v_cache": _w((lambda *s: torch.randn(*s, dtype=torch.bfloat16) * 0.05)(B, Hkv, Sk, Dh)),
            "wq": _w((lambda *s: torch.randn(*s, dtype=torch.bfloat16) * 0.8)(D, Hq * Dh) * (D ** -0.5)),
            "wo": _w((lambda *s: torch.randn(*s, dtype=torch.bfloat16) * 0.05)(Hq * Dh, D) * ((Hq * Dh) ** -0.5)),
        }
    _B_in = _B_setup()

    return {
        "A_x": _A_in["x"],
        "A_k_cache": _A_in["k_cache"],
        "A_v_cache": _A_in["v_cache"],
        "A_wq": _A_in["wq"],
        "A_wo": _A_in["wo"],
        "B_x": _B_in["x"],
        "B_k_cache": _B_in["k_cache"],
        "B_v_cache": _B_in["v_cache"],
        "B_wq": _B_in["wq"],
        "B_wo": _B_in["wo"],
    }

def reference(A_x, A_k_cache, A_v_cache, A_wq, A_wo, B_x, B_k_cache, B_v_cache, B_wq, B_wo):
    def _A_ref(x, k_cache, v_cache, wq, wo):
        B, Sq, D = x.shape
        Hq, Dh = 32, 128
        Hkv = k_cache.shape[1]
        rep = Hq // Hkv
        q = (lambda x, *d: x.permute(*d))((x @ wq).reshape(B, Sq, Hq, Dh), 0, 2, 1, 3)
        k = (lambda x, n, axis: torch.repeat_interleave(x, n, dim=axis))(k_cache, rep, axis=1)
        v = (lambda x, n, axis: torch.repeat_interleave(x, n, dim=axis))(v_cache, rep, axis=1)
        scores = torch.einsum("bhqd,bhkd->bhqk", q, k) * (Dh ** -0.5)
        p = _softmax(scores, axis=-1)
        o = torch.einsum("bhqk,bhkd->bhqd", p, v)
        return (lambda x, *d: x.permute(*d))(o, 0, 2, 1, 3).reshape(B, Sq, Hq * Dh) @ wo

    def _B_ref(x, k_cache, v_cache, wq, wo):
        B, Sq, D = x.shape
        Hq, Dh = 32, 128
        Hkv = k_cache.shape[1]
        rep = Hq // Hkv
        q = (lambda x, *d: x.permute(*d))((x @ wq).reshape(B, Sq, Hq, Dh), 0, 2, 1, 3)
        k = (lambda x, n, axis: torch.repeat_interleave(x, n, dim=axis))(k_cache, rep, axis=1)
        v = (lambda x, n, axis: torch.repeat_interleave(x, n, dim=axis))(v_cache, rep, axis=1)
        scores = torch.einsum("bhqd,bhkd->bhqk", q, k) * (Dh ** -0.5)
        p = _softmax(scores, axis=-1)
        o = torch.einsum("bhqk,bhkd->bhqd", p, v)
        return (lambda x, *d: x.permute(*d))(o, 0, 2, 1, 3).reshape(B, Sq, Hq * Dh) @ wo

    a = _A_ref(A_x, A_k_cache, A_v_cache, A_wq, A_wo)
    b = _B_ref(B_x, B_k_cache, B_v_cache, B_wq, B_wo)
    return torch.concatenate([a, b], axis=-1)
```

```asm
; @launch grid=(256,1,1) block=(512,1,1) lds=163840
.amdgcn_target "amdgcn-amd-amdhsa--gfx950"
.text
.globl concat_heads__gqa_block_cached__gqa_block_cached__near_ridge_kernel
.p2align 8
.type concat_heads__gqa_block_cached__gqa_block_cached__near_ridge_kernel,@function
concat_heads__gqa_block_cached__gqa_block_cached__near_ridge_kernel:
    s_cmp_ge_u32 s2, 256
    s_cbranch_scc1 L_end
    s_load_dwordx8 s[16:23], s[0:1], 0
    s_memrealtime s[96:97]
    s_load_dwordx8 s[24:31], s[0:1], 40
    s_load_dwordx4 s[32:35], s[0:1], 88
    v_lshrrev_b32 v1, 6, v0
    v_and_b32 v2, 63, v0
    v_readfirstlane_b32 s3, v1
    s_and_b32 s4, s2, 7
    s_lshr_b32 s5, s2, 3
    s_lshr_b32 s6, s4, 2
    s_and_b32 s7, s4, 3
    s_lshl_b32 s7, s7, 3
    s_and_b32 s66, s5, 7
    s_add_u32 s7, s7, s66
    s_lshr_b32 s8, s5, 3
    v_lshrrev_b32 v3, 4, v2
    v_and_b32 v4, 15, v2
    s_cmp_lt_u32 s3, 4
    s_cbranch_scc1 L_compute
    s_and_b32 s11, s3, 3
    v_lshrrev_b32 v5, 3, v2
    s_lshl_b32 s12, s11, 3
    v_add_u32 v5, s12, v5
    v_mul_u32_u24 v5, 1280, v5
    s_and_b32 s12, s11, 1
    s_lshl_b32 s12, s12, 2
    v_add_u32 v6, s12, v3
    v_and_b32 v7, 7, v2
    v_xor_b32 v7, v7, v6
    v_lshl_add_u32 v11, v7, 4, v5
    v_lshlrev_b32 v6, 1, v6
    v_xor_b32 v8, v6, v4
    s_lshl_b32 s12, s11, 2
    v_add_u32 v5, s12, v3
    s_lshr_b32 s12, s11, 1
    s_lshl_b32 s12, s12, 2
    v_add_u32 v6, s12, v3
    v_lshlrev_b32 v6, 1, v6
    v_xor_b32 v6, v6, v4
    v_lshlrev_b32 v7, 13, v5
    v_lshl_add_u32 v12, v6, 4, v7
    s_lshl_b32 s13, s11, 10
    s_lshl_b32 s69, s8, 2
    s_lshr_b32 s69, 0x8530, s69
    s_and_b32 s69, s69, 15
    s_lshl_b32 s70, s66, 2
    s_lshr_b32 s70, 0x30630630, s70
    s_and_b32 s70, s70, 15
    s_add_u32 s69, s69, s70
    s_cmp_ge_u32 s69, 10
    s_cselect_b32 s71, 10, 0
    s_sub_u32 s69, s69, s71
    s_and_b32 s70, s4, 3
    s_lshl_b32 s70, s70, 2
    s_lshr_b32 s70, 0x210, s70
    s_and_b32 s70, s70, 15
    s_add_u32 s69, s69, s70
    s_cmp_ge_u32 s69, 10
    s_cselect_b32 s71, 10, 0
    s_sub_u32 s69, s69, s71
    s_mul_i32 s9, s8, 245760
    s_lshl_b32 s10, s7, 8
    s_waitcnt lgkmcnt(0)
    s_cmp_eq_u32 s6, 0
    s_cselect_b64 s[16:17], s[16:17], s[24:25]
    s_cselect_b64 s[18:19], s[18:19], s[26:27]
    s_cselect_b64 s[20:21], s[20:21], s[28:29]
    s_cselect_b64 s[22:23], s[22:23], s[30:31]
    s_add_u32 s36, s16, s9
    s_addc_u32 s37, s17, 0
    s_mov_b32 s38, 245760
    s_mov_b32 s39, 0x20000
    s_add_u32 s40, s22, s10
    s_addc_u32 s41, s23, 0
    s_sub_u32 s42, 5242880, s10
    s_mov_b32 s43, 0x20000
    s_add_u32 s70, s69, 0
    s_cmp_ge_u32 s70, 10
    s_cselect_b32 s71, 10, 0
    s_sub_u32 s70, s70, s71
    s_lshl_b32 s64, s70, 7
    s_add_u32 m0, s13, 24576
    s_add_u32 s14, s64, 0
    buffer_load_dwordx4 v11, s[36:39], s14 offen  lds
    s_add_u32 m0, s13, 28672
    s_add_u32 s14, s64, 40960
    buffer_load_dwordx4 v11, s[36:39], s14 offen  lds
    s_add_u32 m0, s13, 32768
    s_add_u32 s14, s64, 81920
    buffer_load_dwordx4 v11, s[36:39], s14 offen  lds
    s_add_u32 m0, s13, 36864
    s_add_u32 s14, s64, 122880
    buffer_load_dwordx4 v11, s[36:39], s14 offen  lds
    s_add_u32 m0, s13, 40960
    s_add_u32 s14, s64, 163840
    buffer_load_dwordx4 v11, s[36:39], s14 offen  lds
    s_add_u32 m0, s13, 45056
    s_add_u32 s14, s64, 204800
    buffer_load_dwordx4 v11, s[36:39], s14 offen  lds
    s_add_u32 s70, s69, 0
    s_cmp_ge_u32 s70, 10
    s_cselect_b32 s71, 10, 0
    s_sub_u32 s70, s70, s71
    s_lshl_b32 s64, s70, 19
    s_add_u32 m0, s13, 90112
    s_add_u32 s14, s64, 0
    buffer_load_dwordx4 v12, s[40:43], s14 offen  lds
    s_add_u32 m0, s13, 94208
    s_add_u32 s14, s64, 131072
    buffer_load_dwordx4 v12, s[40:43], s14 offen  lds
    s_add_u32 m0, s13, 98304
    s_add_u32 s14, s64, 262144
    buffer_load_dwordx4 v12, s[40:43], s14 offen  lds
    s_add_u32 m0, s13, 102400
    s_add_u32 s14, s64, 393216
    buffer_load_dwordx4 v12, s[40:43], s14 offen  lds
    v_lshlrev_b32 v7, 8, v5
    v_lshl_add_u32 v13, v8, 4, v7
    v_xor_b32 v6, v4, v5
    v_lshl_add_u32 v10, v6, 4, v7
    s_lshl_b32 s12, s8, 6
    s_add_u32 s12, s12, s7
    s_mul_i32 s12, s12, 24576
    s_add_u32 s44, s18, s12
    s_addc_u32 s45, s19, 0
    s_mov_b32 s46, 811008
    s_mov_b32 s47, 0x20000
    s_add_u32 s48, s20, s12
    s_addc_u32 s49, s21, 0
    s_mov_b32 s50, 811008
    s_mov_b32 s51, 0x20000
    s_load_dwordx2 s[16:17], s[0:1], 32
    s_load_dwordx2 s[18:19], s[0:1], 72
    s_mov_b32 s52, s34
    s_and_b32 s53, s35, 0xffff
    s_mov_b32 s54, 50331648
    s_mov_b32 s55, 0x20000
    s_mov_b32 s98, s96
    s_add_u32 s99, s97, 1
    s_mov_b64 s[34:35], s[32:33]
    s_getpc_b64 s[22:23]
L_pc2:
    s_lshl_b32 s9, s5, 2
    s_add_u32 s9, s9, s11
    s_lshl_b32 s9, s9, 8
    s_min_u32 s9, s9, L_end-L_ld2-192
    s_add_u32 s9, s9, L_ld2-L_pc2
    s_add_u32 s22, s22, s9
    s_addc_u32 s23, s23, 0
    s_not_b64 s[20:21], s[96:97]
    s_lshl_b32 s67, s6, 7
    s_lshl_b32 s68, s11, 3
    s_add_u32 s68, s68, s66
    s_add_u32 s70, s69, 1
    s_cmp_ge_u32 s70, 10
    s_cselect_b32 s71, 10, 0
    s_sub_u32 s70, s70, s71
    s_lshl_b32 s64, s70, 7
    s_add_u32 m0, s13, 49152
    s_add_u32 s14, s64, 0
    buffer_load_dwordx4 v11, s[36:39], s14 offen  lds
    s_add_u32 m0, s13, 53248
    s_add_u32 s14, s64, 40960
    buffer_load_dwordx4 v11, s[36:39], s14 offen  lds
    s_add_u32 m0, s13, 57344
    s_add_u32 s14, s64, 81920
    buffer_load_dwordx4 v11, s[36:39], s14 offen  lds
    s_add_u32 m0, s13, 61440
    s_add_u32 s14, s64, 122880
    buffer_load_dwordx4 v11, s[36:39], s14 offen  lds
    s_add_u32 m0, s13, 65536
    s_add_u32 s14, s64, 163840
    buffer_load_dwordx4 v11, s[36:39], s14 offen  lds
    s_add_u32 m0, s13, 69632
    s_add_u32 s14, s64, 204800
    buffer_load_dwordx4 v11, s[36:39], s14 offen  lds
    s_add_u32 s70, s69, 1
    s_cmp_ge_u32 s70, 10
    s_cselect_b32 s71, 10, 0
    s_sub_u32 s70, s70, s71
    s_lshl_b32 s64, s70, 19
    s_add_u32 m0, s13, 106496
    s_add_u32 s14, s64, 0
    buffer_load_dwordx4 v12, s[40:43], s14 offen  lds
    s_waitcnt vmcnt(7)
    s_barrier
    s_cmp_lg_u32 s68, 0
    s_cbranch_scc1 L_nopubA0
    s_atomic_umax_x2 s[20:21], s[34:35], s67 glc
L_nopubA0:
    s_add_u32 m0, s13, 110592
    s_add_u32 s14, s64, 131072
    buffer_load_dwordx4 v12, s[40:43], s14 offen  lds
    s_add_u32 m0, s13, 114688
    s_add_u32 s14, s64, 262144
    buffer_load_dwordx4 v12, s[40:43], s14 offen  lds
    s_add_u32 m0, s13, 118784
    s_add_u32 s14, s64, 393216
    buffer_load_dwordx4 v12, s[40:43], s14 offen  lds
    s_add_u32 s70, s69, 2
    s_cmp_ge_u32 s70, 10
    s_cselect_b32 s71, 10, 0
    s_sub_u32 s70, s70, s71
    s_lshl_b32 s64, s70, 7
    s_add_u32 m0, s13, 0
    s_add_u32 s14, s64, 0
    buffer_load_dwordx4 v11, s[36:39], s14 offen  lds
    s_add_u32 m0, s13, 4096
    s_add_u32 s14, s64, 40960
    buffer_load_dwordx4 v11, s[36:39], s14 offen  lds
    s_add_u32 m0, s13, 8192
    s_add_u32 s14, s64, 81920
    buffer_load_dwordx4 v11, s[36:39], s14 offen  lds
    s_add_u32 m0, s13, 12288
    s_add_u32 s14, s64, 122880
    buffer_load_dwordx4 v11, s[36:39], s14 offen  lds
    s_add_u32 m0, s13, 16384
    s_add_u32 s14, s64, 163840
    buffer_load_dwordx4 v11, s[36:39], s14 offen  lds
    s_add_u32 m0, s13, 20480
    s_add_u32 s14, s64, 204800
    buffer_load_dwordx4 v11, s[36:39], s14 offen  lds
    s_add_u32 s70, s69, 2
    s_cmp_ge_u32 s70, 10
    s_cselect_b32 s71, 10, 0
    s_sub_u32 s70, s70, s71
    s_lshl_b32 s64, s70, 19
    s_add_u32 m0, s13, 73728
    s_add_u32 s14, s64, 0
    buffer_load_dwordx4 v12, s[40:43], s14 offen  lds
    s_waitcnt vmcnt(7)
    s_barrier
    s_cmp_lg_u32 s68, 1
    s_cbranch_scc1 L_nopubA1
    s_atomic_umax_x2 s[20:21], s[34:35], s67 glc
L_nopubA1:
    s_add_u32 m0, s13, 77824
    s_add_u32 s14, s64, 131072
    buffer_load_dwordx4 v12, s[40:43], s14 offen  lds
    s_add_u32 m0, s13, 81920
    s_add_u32 s14, s64, 262144
    buffer_load_dwordx4 v12, s[40:43], s14 offen  lds
    s_add_u32 m0, s13, 86016
    s_add_u32 s14, s64, 393216
    buffer_load_dwordx4 v12, s[40:43], s14 offen  lds
    s_add_u32 s70, s69, 3
    s_cmp_ge_u32 s70, 10
    s_cselect_b32 s71, 10, 0
    s_sub_u32 s70, s70, s71
    s_lshl_b32 s64, s70, 7
    s_add_u32 m0, s13, 24576
    s_add_u32 s14, s64, 0
    buffer_load_dwordx4 v11, s[36:39], s14 offen  lds
    s_add_u32 m0, s13, 28672
    s_add_u32 s14, s64, 40960
    buffer_load_dwordx4 v11, s[36:39], s14 offen  lds
    s_add_u32 m0, s13, 32768
    s_add_u32 s14, s64, 81920
    buffer_load_dwordx4 v11, s[36:39], s14 offen  lds
    s_add_u32 m0, s13, 36864
    s_add_u32 s14, s64, 122880
    buffer_load_dwordx4 v11, s[36:39], s14 offen  lds
    s_add_u32 m0, s13, 40960
    s_add_u32 s14, s64, 163840
    buffer_load_dwordx4 v11, s[36:39], s14 offen  lds
    s_add_u32 m0, s13, 45056
    s_add_u32 s14, s64, 204800
    buffer_load_dwordx4 v11, s[36:39], s14 offen  lds
    s_add_u32 s70, s69, 3
    s_cmp_ge_u32 s70, 10
    s_cselect_b32 s71, 10, 0
    s_sub_u32 s70, s70, s71
    s_lshl_b32 s64, s70, 19
    s_add_u32 m0, s13, 90112
    s_add_u32 s14, s64, 0
    buffer_load_dwordx4 v12, s[40:43], s14 offen  lds
    s_waitcnt vmcnt(7)
    s_barrier
    s_cmp_lg_u32 s68, 2
    s_cbranch_scc1 L_nopubA2
    s_atomic_umax_x2 s[20:21], s[34:35], s67 glc
L_nopubA2:
    s_add_u32 m0, s13, 94208
    s_add_u32 s14, s64, 131072
    buffer_load_dwordx4 v12, s[40:43], s14 offen  lds
    s_add_u32 m0, s13, 98304
    s_add_u32 s14, s64, 262144
    buffer_load_dwordx4 v12, s[40:43], s14 offen  lds
    s_add_u32 m0, s13, 102400
    s_add_u32 s14, s64, 393216
    buffer_load_dwordx4 v12, s[40:43], s14 offen  lds
    s_add_u32 m0, s13, 139264
    s_mov_b32 s14, 786432
    buffer_load_dwordx4 v10, s[44:47], s14 offen nt lds
    s_add_u32 m0, s13, 143360
    s_mov_b32 s14, 790528
    buffer_load_dwordx4 v10, s[44:47], s14 offen nt lds
    s_add_u32 m0, s13, 147456
    s_mov_b32 s14, 794624
    buffer_load_dwordx4 v10, s[44:47], s14 offen nt lds
    s_add_u32 m0, s13, 151552
    s_mov_b32 s14, 798720
    buffer_load_dwordx4 v10, s[44:47], s14 offen nt lds
    s_add_u32 m0, s13, 155648
    s_mov_b32 s14, 802816
    buffer_load_dwordx4 v10, s[44:47], s14 offen nt lds
    s_add_u32 m0, s13, 159744
    s_mov_b32 s14, 806912
    buffer_load_dwordx4 v10, s[44:47], s14 offen nt lds
    s_add_u32 s70, s69, 4
    s_cmp_ge_u32 s70, 10
    s_cselect_b32 s71, 10, 0
    s_sub_u32 s70, s70, s71
    s_lshl_b32 s64, s70, 7
    s_add_u32 m0, s13, 49152
    s_add_u32 s14, s64, 0
    buffer_load_dwordx4 v11, s[36:39], s14 offen  lds
    s_waitcnt vmcnt(7)
    s_barrier
    s_cmp_lg_u32 s68, 3
    s_cbranch_scc1 L_nopubA3
    s_atomic_umax_x2 s[20:21], s[34:35], s67 glc
L_nopubA3:
    s_add_u32 m0, s13, 53248
    s_add_u32 s14, s64, 40960
    buffer_load_dwordx4 v11, s[36:39], s14 offen  lds
    s_add_u32 m0, s13, 57344
    s_add_u32 s14, s64, 81920
    buffer_load_dwordx4 v11, s[36:39], s14 offen  lds
    s_add_u32 m0, s13, 61440
    s_add_u32 s14, s64, 122880
    buffer_load_dwordx4 v11, s[36:39], s14 offen  lds
    s_add_u32 m0, s13, 65536
    s_add_u32 s14, s64, 163840
    buffer_load_dwordx4 v11, s[36:39], s14 offen  lds
    s_add_u32 m0, s13, 69632
    s_add_u32 s14, s64, 204800
    buffer_load_dwordx4 v11, s[36:39], s14 offen  lds
    s_add_u32 s70, s69, 4
    s_cmp_ge_u32 s70, 10
    s_cselect_b32 s71, 10, 0
    s_sub_u32 s70, s70, s71
    s_lshl_b32 s64, s70, 19
    s_add_u32 m0, s13, 106496
    s_add_u32 s14, s64, 0
    buffer_load_dwordx4 v12, s[40:43], s14 offen  lds
    s_add_u32 m0, s13, 110592
    s_add_u32 s14, s64, 131072
    buffer_load_dwordx4 v12, s[40:43], s14 offen  lds
    s_add_u32 m0, s13, 114688
    s_add_u32 s14, s64, 262144
    buffer_load_dwordx4 v12, s[40:43], s14 offen  lds
    s_add_u32 m0, s13, 118784
    s_add_u32 s14, s64, 393216
    buffer_load_dwordx4 v12, s[40:43], s14 offen  lds
    s_add_u32 s70, s69, 5
    s_cmp_ge_u32 s70, 10
    s_cselect_b32 s71, 10, 0
    s_sub_u32 s70, s70, s71
    s_lshl_b32 s64, s70, 7
    s_add_u32 m0, s13, 0
    s_add_u32 s14, s64, 0
    buffer_load_dwordx4 v11, s[36:39], s14 offen  lds
    s_add_u32 m0, s13, 4096
    s_add_u32 s14, s64, 40960
    buffer_load_dwordx4 v11, s[36:39], s14 offen  lds
    s_add_u32 m0, s13, 8192
    s_add_u32 s14, s64, 81920
    buffer_load_dwordx4 v11, s[36:39], s14 offen  lds
    s_add_u32 m0, s13, 12288
    s_add_u32 s14, s64, 122880
    buffer_load_dwordx4 v11, s[36:39], s14 offen  lds
    s_add_u32 m0, s13, 16384
    s_add_u32 s14, s64, 163840
    buffer_load_dwordx4 v11, s[36:39], s14 offen  lds
    s_add_u32 m0, s13, 20480
    s_add_u32 s14, s64, 204800
    buffer_load_dwordx4 v11, s[36:39], s14 offen  lds
    s_add_u32 s70, s69, 5
    s_cmp_ge_u32 s70, 10
    s_cselect_b32 s71, 10, 0
    s_sub_u32 s70, s70, s71
    s_lshl_b32 s64, s70, 19
    s_add_u32 m0, s13, 73728
    s_add_u32 s14, s64, 0
    buffer_load_dwordx4 v12, s[40:43], s14 offen  lds
    s_waitcnt vmcnt(7)
    s_barrier
    s_cmp_lg_u32 s68, 4
    s_cbranch_scc1 L_nopubA4
    s_atomic_umax_x2 s[20:21], s[34:35], s67 glc
L_nopubA4:
    s_add_u32 m0, s13, 77824
    s_add_u32 s14, s64, 131072
    buffer_load_dwordx4 v12, s[40:43], s14 offen  lds
    s_add_u32 m0, s13, 81920
    s_add_u32 s14, s64, 262144
    buffer_load_dwordx4 v12, s[40:43], s14 offen  lds
    s_add_u32 m0, s13, 86016
    s_add_u32 s14, s64, 393216
    buffer_load_dwordx4 v12, s[40:43], s14 offen  lds
    s_add_u32 m0, s13, 122880
    s_mov_b32 s14, 8192
    buffer_load_dwordx4 v10, s[44:47], s14 offen nt lds
    s_add_u32 m0, s13, 126976
    s_mov_b32 s14, 12288
    buffer_load_dwordx4 v10, s[44:47], s14 offen nt lds
    s_add_u32 m0, s13, 131072
    s_mov_b32 s14, 16384
    buffer_load_dwordx4 v10, s[44:47], s14 offen nt lds
    s_add_u32 m0, s13, 135168
    s_mov_b32 s14, 20480
    buffer_load_dwordx4 v10, s[44:47], s14 offen nt lds
    s_mov_b32 s14, 0
    buffer_load_dwordx4 v[32:35], v10, s[44:47], s14 offen nt
    s_mov_b32 s14, 4096
    buffer_load_dwordx4 v[36:39], v10, s[44:47], s14 offen nt
    s_add_u32 s70, s69, 6
    s_cmp_ge_u32 s70, 10
    s_cselect_b32 s71, 10, 0
    s_sub_u32 s70, s70, s71
    s_lshl_b32 s64, s70, 7
    s_add_u32 m0, s13, 24576
    s_add_u32 s14, s64, 0
    buffer_load_dwordx4 v11, s[36:39], s14 offen  lds
    s_waitcnt vmcnt(7)
    s_barrier
    s_cmp_lg_u32 s68, 5
    s_cbranch_scc1 L_nopubA5
    s_atomic_umax_x2 s[20:21], s[34:35], s67 glc
L_nopubA5:
    s_add_u32 m0, s13, 28672
    s_add_u32 s14, s64, 40960
    buffer_load_dwordx4 v11, s[36:39], s14 offen  lds
    s_add_u32 m0, s13, 32768
    s_add_u32 s14, s64, 81920
    buffer_load_dwordx4 v11, s[36:39], s14 offen  lds
    s_add_u32 m0, s13, 36864
    s_add_u32 s14, s64, 122880
    buffer_load_dwordx4 v11, s[36:39], s14 offen  lds
    s_add_u32 m0, s13, 40960
    s_add_u32 s14, s64, 163840
    buffer_load_dwordx4 v11, s[36:39], s14 offen  lds
    s_add_u32 m0, s13, 45056
    s_add_u32 s14, s64, 204800
    buffer_load_dwordx4 v11, s[36:39], s14 offen  lds
    s_add_u32 s70, s69, 6
    s_cmp_ge_u32 s70, 10
    s_cselect_b32 s71, 10, 0
    s_sub_u32 s70, s70, s71
    s_lshl_b32 s64, s70, 19
    s_add_u32 m0, s13, 90112
    s_add_u32 s14, s64, 0
    buffer_load_dwordx4 v12, s[40:43], s14 offen  lds
    s_add_u32 m0, s13, 94208
    s_add_u32 s14, s64, 131072
    buffer_load_dwordx4 v12, s[40:43], s14 offen  lds
    s_add_u32 m0, s13, 98304
    s_add_u32 s14, s64, 262144
    buffer_load_dwordx4 v12, s[40:43], s14 offen  lds
    s_add_u32 m0, s13, 102400
    s_add_u32 s14, s64, 393216
    buffer_load_dwordx4 v12, s[40:43], s14 offen  lds
    s_add_u32 s70, s69, 7
    s_cmp_ge_u32 s70, 10
    s_cselect_b32 s71, 10, 0
    s_sub_u32 s70, s70, s71
    s_lshl_b32 s64, s70, 7
    s_add_u32 m0, s13, 49152
    s_add_u32 s14, s64, 0
    buffer_load_dwordx4 v11, s[36:39], s14 offen  lds
    s_add_u32 m0, s13, 53248
    s_add_u32 s14, s64, 40960
    buffer_load_dwordx4 v11, s[36:39], s14 offen  lds
    s_add_u32 m0, s13, 57344
    s_add_u32 s14, s64, 81920
    buffer_load_dwordx4 v11, s[36:39], s14 offen  lds
    s_add_u32 m0, s13, 61440
    s_add_u32 s14, s64, 122880
    buffer_load_dwordx4 v11, s[36:39], s14 offen  lds
    s_add_u32 m0, s13, 65536
    s_add_u32 s14, s64, 163840
    buffer_load_dwordx4 v11, s[36:39], s14 offen  lds
    s_add_u32 m0, s13, 69632
    s_add_u32 s14, s64, 204800
    buffer_load_dwordx4 v11, s[36:39], s14 offen  lds
    s_add_u32 s70, s69, 7
    s_cmp_ge_u32 s70, 10
    s_cselect_b32 s71, 10, 0
    s_sub_u32 s70, s70, s71
    s_lshl_b32 s64, s70, 19
    s_add_u32 m0, s13, 106496
    s_add_u32 s14, s64, 0
    buffer_load_dwordx4 v12, s[40:43], s14 offen  lds
    s_waitcnt vmcnt(7)
    s_barrier
    s_cmp_lg_u32 s68, 6
    s_cbranch_scc1 L_nopubA6
    s_atomic_umax_x2 s[20:21], s[34:35], s67 glc
L_nopubA6:
    s_add_u32 m0, s13, 110592
    s_add_u32 s14, s64, 131072
    buffer_load_dwordx4 v12, s[40:43], s14 offen  lds
    s_add_u32 m0, s13, 114688
    s_add_u32 s14, s64, 262144
    buffer_load_dwordx4 v12, s[40:43], s14 offen  lds
    s_add_u32 m0, s13, 118784
    s_add_u32 s14, s64, 393216
    buffer_load_dwordx4 v12, s[40:43], s14 offen  lds
    s_mov_b32 s14, 0
    buffer_load_dwordx4 v[40:43], v13, s[48:51], s14 offen nt
    s_mov_b32 s14, 4096
    buffer_load_dwordx4 v[44:47], v13, s[48:51], s14 offen nt
    s_mov_b32 s14, 8192
    buffer_load_dwordx4 v[48:51], v13, s[48:51], s14 offen nt
    s_mov_b32 s14, 12288
    buffer_load_dwordx4 v[52:55], v13, s[48:51], s14 offen nt
    s_mov_b32 s14, 16384
    buffer_load_dwordx4 v[56:59], v13, s[48:51], s14 offen nt
    s_mov_b32 s14, 20480
    buffer_load_dwordx4 v[60:63], v13, s[48:51], s14 offen nt
    s_add_u32 s70, s69, 8
    s_cmp_ge_u32 s70, 10
    s_cselect_b32 s71, 10, 0
    s_sub_u32 s70, s70, s71
    s_lshl_b32 s64, s70, 7
    s_add_u32 m0, s13, 0
    s_add_u32 s14, s64, 0
    buffer_load_dwordx4 v11, s[36:39], s14 offen  lds
    s_waitcnt vmcnt(7)
    s_barrier
    s_cmp_lg_u32 s68, 7
    s_cbranch_scc1 L_nopubA7
    s_atomic_umax_x2 s[20:21], s[34:35], s67 glc
L_nopubA7:
    s_load_dword s24, s[22:23], 0x0
    s_load_dword s25, s[22:23], 0x40
    s_load_dword s24, s[22:23], 0x80
    s_load_dword s25, s[22:23], 0xc0
    s_add_u32 m0, s13, 4096
    s_add_u32 s14, s64, 40960
    buffer_load_dwordx4 v11, s[36:39], s14 offen  lds
    s_add_u32 m0, s13, 8192
    s_add_u32 s14, s64, 81920
    buffer_load_dwordx4 v11, s[36:39], s14 offen  lds
    s_add_u32 m0, s13, 12288
    s_add_u32 s14, s64, 122880
    buffer_load_dwordx4 v11, s[36:39], s14 offen  lds
    s_add_u32 m0, s13, 16384
    s_add_u32 s14, s64, 163840
    buffer_load_dwordx4 v11, s[36:39], s14 offen  lds
    s_add_u32 m0, s13, 20480
    s_add_u32 s14, s64, 204800
    buffer_load_dwordx4 v11, s[36:39], s14 offen  lds
    s_add_u32 s70, s69, 8
    s_cmp_ge_u32 s70, 10
    s_cselect_b32 s71, 10, 0
    s_sub_u32 s70, s70, s71
    s_lshl_b32 s64, s70, 19
    s_add_u32 m0, s13, 73728
    s_add_u32 s14, s64, 0
    buffer_load_dwordx4 v12, s[40:43], s14 offen  lds
    s_add_u32 m0, s13, 77824
    s_add_u32 s14, s64, 131072
    buffer_load_dwordx4 v12, s[40:43], s14 offen  lds
    s_add_u32 m0, s13, 81920
    s_add_u32 s14, s64, 262144
    buffer_load_dwordx4 v12, s[40:43], s14 offen  lds
    s_add_u32 m0, s13, 86016
    s_add_u32 s14, s64, 393216
    buffer_load_dwordx4 v12, s[40:43], s14 offen  lds
    s_add_u32 s70, s69, 9
    s_cmp_ge_u32 s70, 10
    s_cselect_b32 s71, 10, 0
    s_sub_u32 s70, s70, s71
    s_lshl_b32 s64, s70, 7
    s_add_u32 m0, s13, 24576
    s_add_u32 s14, s64, 0
    buffer_load_dwordx4 v11, s[36:39], s14 offen  lds
    s_add_u32 m0, s13, 28672
    s_add_u32 s14, s64, 40960
    buffer_load_dwordx4 v11, s[36:39], s14 offen  lds
    s_add_u32 m0, s13, 32768
    s_add_u32 s14, s64, 81920
    buffer_load_dwordx4 v11, s[36:39], s14 offen  lds
    s_add_u32 m0, s13, 36864
    s_add_u32 s14, s64, 122880
    buffer_load_dwordx4 v11, s[36:39], s14 offen  lds
    s_add_u32 m0, s13, 40960
    s_add_u32 s14, s64, 163840
    buffer_load_dwordx4 v11, s[36:39], s14 offen  lds
    s_add_u32 m0, s13, 45056
    s_add_u32 s14, s64, 204800
    buffer_load_dwordx4 v11, s[36:39], s14 offen  lds
    s_add_u32 s70, s69, 9
    s_cmp_ge_u32 s70, 10
    s_cselect_b32 s71, 10, 0
    s_sub_u32 s70, s70, s71
    s_lshl_b32 s64, s70, 19
    s_add_u32 m0, s13, 90112
    s_add_u32 s14, s64, 0
    buffer_load_dwordx4 v12, s[40:43], s14 offen  lds
    s_add_u32 m0, s13, 94208
    s_add_u32 s14, s64, 131072
    buffer_load_dwordx4 v12, s[40:43], s14 offen  lds
    s_add_u32 m0, s13, 98304
    s_add_u32 s14, s64, 262144
    buffer_load_dwordx4 v12, s[40:43], s14 offen  lds
    s_add_u32 m0, s13, 102400
    s_add_u32 s14, s64, 393216
    buffer_load_dwordx4 v12, s[40:43], s14 offen  lds
    s_waitcnt vmcnt(10)
    s_barrier
    s_mov_b32 s14, 786432
    buffer_load_dwordx4 v[64:67], v13, s[48:51], s14 offen nt
    s_mov_b32 s14, 790528
    buffer_load_dwordx4 v[68:71], v13, s[48:51], s14 offen nt
    s_mov_b32 s14, 794624
    buffer_load_dwordx4 v[72:75], v13, s[48:51], s14 offen nt
    s_mov_b32 s14, 798720
    buffer_load_dwordx4 v[76:79], v13, s[48:51], s14 offen nt
    s_mov_b32 s14, 802816
    buffer_load_dwordx4 v[80:83], v13, s[48:51], s14 offen nt
    s_mov_b32 s14, 806912
    buffer_load_dwordx4 v[84:87], v13, s[48:51], s14 offen nt
    s_waitcnt lgkmcnt(0)
    s_cmp_eq_u32 s6, 0
    s_cselect_b64 s[28:29], s[16:17], s[18:19]
    s_mov_b32 s30, 5242880
    s_mov_b32 s31, 0x20000
    s_and_b32 s62, s4, 3
    s_lshl_b32 s62, s62, 3
    s_lshr_b32 s9, s5, 2
    s_add_u32 s62, s62, s9
    s_lshl_b32 s62, s62, 3
    s_and_b32 s9, s5, 3
    s_add_u32 s62, s62, s9
    s_mul_i32 s62, s62, 20480
    v_lshl_add_u32 v15, v2, 4, s13
    s_add_u32 s14, s62, 0
    buffer_load_dwordx4 v[20:23], v15, s[28:31], s14 offen
    s_add_u32 s14, s62, 4096
    buffer_load_dwordx4 v[20:23], v15, s[28:31], s14 offen
    s_add_u32 s14, s62, 8192
    buffer_load_dwordx4 v[20:23], v15, s[28:31], s14 offen
    s_add_u32 s14, s62, 12288
    buffer_load_dwordx4 v[20:23], v15, s[28:31], s14 offen
    s_waitcnt vmcnt(10)
    v_lshl_add_u32 v15, v2, 4, s13
    v_add_u32 v16, 0x10000, v15
    ds_write_b128 v16, v[32:35] offset:49152
    ds_write_b128 v16, v[36:39] offset:53248
    s_waitcnt lgkmcnt(0)
    s_barrier
    s_add_u32 s14, s62, 16384
    buffer_load_dwordx4 v[20:23], v15, s[28:31], s14 offen
    s_add_u32 s14, s62, 81920
    buffer_load_dwordx4 v[20:23], v15, s[28:31], s14 offen
    s_add_u32 s14, s62, 86016
    buffer_load_dwordx4 v[20:23], v15, s[28:31], s14 offen
    s_add_u32 s14, s62, 90112
    buffer_load_dwordx4 v[20:23], v15, s[28:31], s14 offen
    s_add_u32 s14, s62, 94208
    buffer_load_dwordx4 v[20:23], v15, s[28:31], s14 offen
    s_add_u32 s14, s62, 98304
    buffer_load_dwordx4 v[20:23], v15, s[28:31], s14 offen
    s_waitcnt vmcnt(16)
    s_waitcnt vmcnt(10)
    ds_write_b128 v15, v[40:43] offset:49152
    ds_write_b128 v15, v[44:47] offset:53248
    ds_write_b128 v15, v[48:51] offset:57344
    ds_write_b128 v15, v[52:55] offset:61440
    ds_write_b128 v16, v[56:59] offset:0
    ds_write_b128 v16, v[60:63] offset:4096
    ds_write_b128 v15, v[64:67] offset:0
    ds_write_b128 v15, v[68:71] offset:4096
    ds_write_b128 v15, v[72:75] offset:8192
    ds_write_b128 v15, v[76:79] offset:12288
    ds_write_b128 v15, v[80:83] offset:16384
    ds_write_b128 v15, v[84:87] offset:20480
    s_waitcnt vmcnt(10)
    s_waitcnt lgkmcnt(0)
    s_barrier
L_ld2:
    s_cmp_ge_u32 s5, 30
    s_cbranch_scc1 L_ld_idle
    s_mul_i32 s66, s5, 52
    s_lshr_b32 s66, s66, 8
    s_mul_i32 s67, s66, 5
    s_sub_u32 s67, s5, s67
    s_and_b32 s10, s4, 3
    s_waitcnt lgkmcnt(0)
    s_cmp_eq_u32 s6, 0
    s_cselect_b64 s[16:17], s[16:17], s[18:19]
    s_mul_i32 s9, s10, 1310720
    s_lshl_b32 s12, s67, 8
    s_add_u32 s9, s9, s12
    s_add_u32 s36, s16, s9
    s_addc_u32 s37, s17, 0
    s_sub_u32 s38, 1310720, s12
    s_mov_b32 s39, 0x20000
    v_mul_u32_u24 v7, 1280, v5
    v_lshl_add_u32 v12, v8, 4, v7
    v_lshl_add_u32 v11, v2, 4, s13
    s_mul_i32 s69, s66, 43
    s_lshr_b32 s69, s69, 4
    s_mul_i32 s70, s67, 0
    s_add_u32 s69, s69, s70
    s_and_b32 s69, s69, 14
    s_mul_i32 s65, s4, 1601536
    s_lshl_b32 s12, s66, 13
    s_add_u32 s65, s65, s12
    s_add_u32 s65, s65, 4096
    s_mul_i32 s70, s69, 81920
    s_mul_i32 s71, s69, 98304
    s_add_u32 s71, s71, s65
    s_add_u32 s63, s65, 1572864
    s_mul_i32 s12, s66, 171
    s_lshr_b32 s12, s12, 6
    s_lshl_b32 s12, s12, 6
    s_mul_i32 s14, s4, 1601536
    s_add_u32 s12, s12, s14
    s_add_u32 s15, s12, 1576960
    s_cmp_eq_u32 s66, 1
    s_cselect_b32 s20, -1, 0xffffff
    s_cmp_eq_u32 s66, 4
    s_cselect_b32 s20, -1, s20
    s_mov_b32 s21, 0
    v_lshlrev_b32 v14, 3, v2
    s_barrier
    s_add_u32 m0, s13, 81920
    s_add_u32 s14, s70, 0
    buffer_load_dwordx4 v12, s[36:39], s14 offen  lds
    s_add_u32 m0, s13, 86016
    s_add_u32 s14, s70, 20480
    buffer_load_dwordx4 v12, s[36:39], s14 offen  lds
    s_add_u32 m0, s13, 90112
    s_add_u32 s14, s70, 40960
    buffer_load_dwordx4 v12, s[36:39], s14 offen  lds
    s_add_u32 m0, s13, 94208
    s_add_u32 s14, s70, 61440
    buffer_load_dwordx4 v12, s[36:39], s14 offen  lds
    s_add_u32 s70, s70, 163840
    s_cmp_ge_u32 s70, 1310720
    s_cselect_b32 s12, 1310720, 0
    s_sub_u32 s70, s70, s12
    s_add_u32 m0, s13, 98304
    s_add_u32 s14, s70, 0
    buffer_load_dwordx4 v12, s[36:39], s14 offen  lds
    s_add_u32 m0, s13, 102400
    s_add_u32 s14, s70, 20480
    buffer_load_dwordx4 v12, s[36:39], s14 offen  lds
    s_add_u32 m0, s13, 106496
    s_add_u32 s14, s70, 40960
    buffer_load_dwordx4 v12, s[36:39], s14 offen  lds
    s_add_u32 m0, s13, 110592
    s_add_u32 s14, s70, 61440
    buffer_load_dwordx4 v12, s[36:39], s14 offen  lds
    s_add_u32 s70, s70, 163840
    s_cmp_ge_u32 s70, 1310720
    s_cselect_b32 s12, 1310720, 0
    s_sub_u32 s70, s70, s12
    s_add_u32 m0, s13, 114688
    s_add_u32 s14, s70, 0
    buffer_load_dwordx4 v12, s[36:39], s14 offen  lds
    s_add_u32 m0, s13, 118784
    s_add_u32 s14, s70, 20480
    buffer_load_dwordx4 v12, s[36:39], s14 offen  lds
    s_add_u32 m0, s13, 122880
    s_add_u32 s14, s70, 40960
    buffer_load_dwordx4 v12, s[36:39], s14 offen  lds
    s_add_u32 m0, s13, 126976
    s_add_u32 s14, s70, 61440
    buffer_load_dwordx4 v12, s[36:39], s14 offen  lds
    s_add_u32 s70, s70, 163840
    s_cmp_ge_u32 s70, 1310720
    s_cselect_b32 s12, 1310720, 0
    s_sub_u32 s70, s70, s12
    s_add_u32 m0, s13, 131072
    s_add_u32 s14, s70, 0
    buffer_load_dwordx4 v12, s[36:39], s14 offen  lds
    s_add_u32 m0, s13, 135168
    s_add_u32 s14, s70, 20480
    buffer_load_dwordx4 v12, s[36:39], s14 offen  lds
    s_add_u32 m0, s13, 139264
    s_add_u32 s14, s70, 40960
    buffer_load_dwordx4 v12, s[36:39], s14 offen  lds
    s_add_u32 m0, s13, 143360
    s_add_u32 s14, s70, 61440
    buffer_load_dwordx4 v12, s[36:39], s14 offen  lds
    s_add_u32 s70, s70, 163840
    s_cmp_ge_u32 s70, 1310720
    s_cselect_b32 s12, 1310720, 0
    s_sub_u32 s70, s70, s12
    s_add_u32 m0, s13, 147456
    s_add_u32 s14, s70, 0
    buffer_load_dwordx4 v12, s[36:39], s14 offen  lds
    s_add_u32 m0, s13, 151552
    s_add_u32 s14, s70, 20480
    buffer_load_dwordx4 v12, s[36:39], s14 offen  lds
    s_add_u32 m0, s13, 155648
    s_add_u32 s14, s70, 40960
    buffer_load_dwordx4 v12, s[36:39], s14 offen  lds
    s_add_u32 m0, s13, 159744
    s_add_u32 s14, s70, 61440
    buffer_load_dwordx4 v12, s[36:39], s14 offen  lds
    s_add_u32 s70, s70, 163840
    s_cmp_ge_u32 s70, 1310720
    s_cselect_b32 s12, 1310720, 0
    s_sub_u32 s70, s70, s12
    s_add_u32 m0, s13, 65536
    s_add_u32 s14, s70, 0
    buffer_load_dwordx4 v12, s[36:39], s14 offen  lds
    s_add_u32 m0, s13, 69632
    s_add_u32 s14, s70, 20480
    buffer_load_dwordx4 v12, s[36:39], s14 offen  lds
    s_add_u32 m0, s13, 73728
    s_add_u32 s14, s70, 40960
    buffer_load_dwordx4 v12, s[36:39], s14 offen  lds
    s_add_u32 m0, s13, 77824
    s_add_u32 s14, s70, 61440
    buffer_load_dwordx4 v12, s[36:39], s14 offen  lds
    s_add_u32 s70, s70, 163840
    s_cmp_ge_u32 s70, 1310720
    s_cselect_b32 s12, 1310720, 0
    s_sub_u32 s70, s70, s12
    s_cmp_lg_u32 s3, 4
    s_cbranch_scc1 L_nopoll
    s_mov_b32 s9, 16777216
    s_mov_b64 exec, s[20:21]
L_pf1:
    buffer_load_dwordx2 v[16:17], v14, s[52:55], s15 offen sc1
    s_waitcnt vmcnt(0)
    v_cmp_gt_u64 vcc, s[96:97], v[16:17]
    v_cmp_lt_u64 s[100:101], s[98:99], v[16:17]
    s_nop 0
    s_or_b64 vcc, vcc, s[100:101]
    s_cbranch_scc0 L_pf1_ok
    s_sleep 2
    s_sub_u32 s9, s9, 1
    s_and_b32 s100, s9, 127
    s_cbranch_scc1 L_pf1
    s_lshl_b32 s100, s6, 7
    s_load_dwordx2 s[100:101], s[34:35], s100 glc
    s_waitcnt lgkmcnt(0)
    s_cmp_eq_u64 s[100:101], 0
    s_cbranch_scc1 L_pf1_nz
    s_not_b64 s[96:97], s[100:101]
L_pf1_nz:
    s_cmp_lg_u32 s9, 0
    s_cbranch_scc1 L_pf1
L_pf1_ok:
    s_mov_b64 exec, -1
L_nopoll:
    s_barrier
    s_add_u32 m0, s13, 0
    s_add_u32 s14, s71, 0
    buffer_load_dwordx4 v11, s[52:55], s14 offen sc1 lds
    s_add_u32 m0, s13, 4096
    s_add_u32 s14, s71, 4096
    buffer_load_dwordx4 v11, s[52:55], s14 offen sc1 lds
    s_add_u32 m0, s13, 8192
    s_add_u32 s14, s71, 49152
    buffer_load_dwordx4 v11, s[52:55], s14 offen sc1 lds
    s_add_u32 m0, s13, 12288
    s_add_u32 s14, s71, 53248
    buffer_load_dwordx4 v11, s[52:55], s14 offen sc1 lds
    s_add_u32 s71, s71, 196608
    s_cmp_ge_u32 s71, s63
    s_cselect_b32 s12, 1572864, 0
    s_sub_u32 s71, s71, s12
    s_add_u32 m0, s13, 16384
    s_add_u32 s14, s71, 0
    buffer_load_dwordx4 v11, s[52:55], s14 offen sc1 lds
    s_add_u32 m0, s13, 20480
    s_add_u32 s14, s71, 4096
    buffer_load_dwordx4 v11, s[52:55], s14 offen sc1 lds
    s_add_u32 m0, s13, 24576
    s_add_u32 s14, s71, 49152
    buffer_load_dwordx4 v11, s[52:55], s14 offen sc1 lds
    s_add_u32 m0, s13, 28672
    s_add_u32 s14, s71, 53248
    buffer_load_dwordx4 v11, s[52:55], s14 offen sc1 lds
    s_add_u32 s71, s71, 196608
    s_cmp_ge_u32 s71, s63
    s_cselect_b32 s12, 1572864, 0
    s_sub_u32 s71, s71, s12
    s_add_u32 m0, s13, 32768
    s_add_u32 s14, s71, 0
    buffer_load_dwordx4 v11, s[52:55], s14 offen sc1 lds
    s_add_u32 m0, s13, 36864
    s_add_u32 s14, s71, 4096
    buffer_load_dwordx4 v11, s[52:55], s14 offen sc1 lds
    s_add_u32 m0, s13, 40960
    s_add_u32 s14, s71, 49152
    buffer_load_dwordx4 v11, s[52:55], s14 offen sc1 lds
    s_add_u32 m0, s13, 45056
    s_add_u32 s14, s71, 53248
    buffer_load_dwordx4 v11, s[52:55], s14 offen sc1 lds
    s_add_u32 s71, s71, 196608
    s_cmp_ge_u32 s71, s63
    s_cselect_b32 s12, 1572864, 0
    s_sub_u32 s71, s71, s12
    s_add_u32 m0, s13, 49152
    s_add_u32 s14, s71, 0
    buffer_load_dwordx4 v11, s[52:55], s14 offen sc1 lds
    s_add_u32 m0, s13, 53248
    s_add_u32 s14, s71, 4096
    buffer_load_dwordx4 v11, s[52:55], s14 offen sc1 lds
    s_add_u32 m0, s13, 57344
    s_add_u32 s14, s71, 49152
    buffer_load_dwordx4 v11, s[52:55], s14 offen sc1 lds
    s_add_u32 m0, s13, 61440
    s_add_u32 s14, s71, 53248
    buffer_load_dwordx4 v11, s[52:55], s14 offen sc1 lds
    s_add_u32 s71, s71, 196608
    s_cmp_ge_u32 s71, s63
    s_cselect_b32 s12, 1572864, 0
    s_sub_u32 s71, s71, s12
    s_waitcnt vmcnt(12)
    s_barrier
    s_waitcnt vmcnt(8)
    s_barrier
    s_add_u32 m0, s13, 0
    s_add_u32 s14, s71, 0
    buffer_load_dwordx4 v11, s[52:55], s14 offen sc1 lds
    s_add_u32 m0, s13, 4096
    s_add_u32 s14, s71, 4096
    buffer_load_dwordx4 v11, s[52:55], s14 offen sc1 lds
    s_add_u32 m0, s13, 8192
    s_add_u32 s14, s71, 49152
    buffer_load_dwordx4 v11, s[52:55], s14 offen sc1 lds
    s_add_u32 m0, s13, 12288
    s_add_u32 s14, s71, 53248
    buffer_load_dwordx4 v11, s[52:55], s14 offen sc1 lds
    s_add_u32 s71, s71, 196608
    s_cmp_ge_u32 s71, s63
    s_cselect_b32 s12, 1572864, 0
    s_sub_u32 s71, s71, s12
    s_add_u32 m0, s13, 81920
    s_add_u32 s14, s70, 0
    buffer_load_dwordx4 v12, s[36:39], s14 offen  lds
    s_add_u32 m0, s13, 86016
    s_add_u32 s14, s70, 20480
    buffer_load_dwordx4 v12, s[36:39], s14 offen  lds
    s_add_u32 m0, s13, 90112
    s_add_u32 s14, s70, 40960
    buffer_load_dwordx4 v12, s[36:39], s14 offen  lds
    s_add_u32 m0, s13, 94208
    s_add_u32 s14, s70, 61440
    buffer_load_dwordx4 v12, s[36:39], s14 offen  lds
    s_add_u32 s70, s70, 163840
    s_cmp_ge_u32 s70, 1310720
    s_cselect_b32 s12, 1310720, 0
    s_sub_u32 s70, s70, s12
    s_waitcnt vmcnt(12)
    s_barrier
    s_add_u32 m0, s13, 16384
    s_add_u32 s14, s71, 0
    buffer_load_dwordx4 v11, s[52:55], s14 offen sc1 lds
    s_add_u32 m0, s13, 20480
    s_add_u32 s14, s71, 4096
    buffer_load_dwordx4 v11, s[52:55], s14 offen sc1 lds
    s_add_u32 m0, s13, 24576
    s_add_u32 s14, s71, 49152
    buffer_load_dwordx4 v11, s[52:55], s14 offen sc1 lds
    s_add_u32 m0, s13, 28672
    s_add_u32 s14, s71, 53248
    buffer_load_dwordx4 v11, s[52:55], s14 offen sc1 lds
    s_add_u32 s71, s71, 196608
    s_cmp_ge_u32 s71, s63
    s_cselect_b32 s12, 1572864, 0
    s_sub_u32 s71, s71, s12
    s_mov_b64 exec, s[20:21]
    buffer_load_dwordx2 v[16:17], v14, s[52:55], s15 offen offset:1024 sc1
    s_mov_b64 exec, -1
    s_add_u32 m0, s13, 98304
    s_add_u32 s14, s70, 0
    buffer_load_dwordx4 v12, s[36:39], s14 offen  lds
    s_add_u32 m0, s13, 102400
    s_add_u32 s14, s70, 20480
    buffer_load_dwordx4 v12, s[36:39], s14 offen  lds
    s_add_u32 m0, s13, 106496
    s_add_u32 s14, s70, 40960
    buffer_load_dwordx4 v12, s[36:39], s14 offen  lds
    s_add_u32 m0, s13, 110592
    s_add_u32 s14, s70, 61440
    buffer_load_dwordx4 v12, s[36:39], s14 offen  lds
    s_add_u32 s70, s70, 163840
    s_cmp_ge_u32 s70, 1310720
    s_cselect_b32 s12, 1310720, 0
    s_sub_u32 s70, s70, s12
    s_add_u32 s70, s70, 81920
    s_waitcnt vmcnt(17)
    s_barrier
    s_add_u32 m0, s13, 32768
    s_add_u32 s14, s71, 0
    buffer_load_dwordx4 v11, s[52:55], s14 offen sc1 lds
    s_add_u32 m0, s13, 36864
    s_add_u32 s14, s71, 4096
    buffer_load_dwordx4 v11, s[52:55], s14 offen sc1 lds
    s_add_u32 m0, s13, 40960
    s_add_u32 s14, s71, 49152
    buffer_load_dwordx4 v11, s[52:55], s14 offen sc1 lds
    s_add_u32 m0, s13, 45056
    s_add_u32 s14, s71, 53248
    buffer_load_dwordx4 v11, s[52:55], s14 offen sc1 lds
    s_add_u32 s71, s71, 196608
    s_cmp_ge_u32 s71, s63
    s_cselect_b32 s12, 1572864, 0
    s_sub_u32 s71, s71, s12
    s_waitcnt vmcnt(17)
    s_barrier
    s_add_u32 m0, s13, 49152
    s_add_u32 s14, s71, 0
    buffer_load_dwordx4 v11, s[52:55], s14 offen sc1 lds
    s_add_u32 m0, s13, 53248
    s_add_u32 s14, s71, 4096
    buffer_load_dwordx4 v11, s[52:55], s14 offen sc1 lds
    s_add_u32 m0, s13, 57344
    s_add_u32 s14, s71, 49152
    buffer_load_dwordx4 v11, s[52:55], s14 offen sc1 lds
    s_add_u32 m0, s13, 61440
    s_add_u32 s14, s71, 53248
    buffer_load_dwordx4 v11, s[52:55], s14 offen sc1 lds
    s_add_u32 s71, s71, 196608
    s_cmp_ge_u32 s71, s63
    s_cselect_b32 s12, 1572864, 0
    s_sub_u32 s71, s71, s12
    s_add_u32 s71, s71, 98304
    s_add_u32 m0, s13, 114688
    s_add_u32 s14, s70, 0
    buffer_load_dwordx4 v12, s[36:39], s14 offen  lds
    s_add_u32 m0, s13, 118784
    s_add_u32 s14, s70, 20480
    buffer_load_dwordx4 v12, s[36:39], s14 offen  lds
    s_add_u32 m0, s13, 122880
    s_add_u32 s14, s70, 40960
    buffer_load_dwordx4 v12, s[36:39], s14 offen  lds
    s_add_u32 m0, s13, 126976
    s_add_u32 s14, s70, 61440
    buffer_load_dwordx4 v12, s[36:39], s14 offen  lds
    s_add_u32 s70, s70, 163840
    s_cmp_ge_u32 s70, 1310720
    s_cselect_b32 s12, 1310720, 0
    s_sub_u32 s70, s70, s12
    s_waitcnt vmcnt(17)
    s_barrier
    s_waitcnt vmcnt(16)
    s_mov_b64 exec, s[20:21]
    v_cmp_gt_u64 vcc, s[96:97], v[16:17]
    v_cmp_lt_u64 s[100:101], s[98:99], v[16:17]
    s_mov_b64 exec, -1
    s_or_b64 vcc, vcc, s[100:101]
    s_cbranch_scc0 L_fb_ok
    s_add_u32 s15, s15, 1024
    s_mov_b32 s9, 16777216
    s_mov_b64 exec, s[20:21]
L_pf1b:
    buffer_load_dwordx2 v[16:17], v14, s[52:55], s15 offen sc1
    s_waitcnt vmcnt(0)
    v_cmp_gt_u64 vcc, s[96:97], v[16:17]
    v_cmp_lt_u64 s[100:101], s[98:99], v[16:17]
    s_nop 0
    s_or_b64 vcc, vcc, s[100:101]
    s_cbranch_scc0 L_pf1b_ok
    s_sleep 2
    s_sub_u32 s9, s9, 1
    s_and_b32 s100, s9, 127
    s_cbranch_scc1 L_pf1b
    s_lshl_b32 s100, s6, 7
    s_load_dwordx2 s[100:101], s[34:35], s100 glc
    s_waitcnt lgkmcnt(0)
    s_cmp_eq_u64 s[100:101], 0
    s_cbranch_scc1 L_pf1b_nz
    s_not_b64 s[96:97], s[100:101]
L_pf1b_nz:
    s_cmp_lg_u32 s9, 0
    s_cbranch_scc1 L_pf1b
L_pf1b_ok:
    s_mov_b64 exec, -1
L_fb_ok:
    s_add_u32 m0, s13, 0
    s_add_u32 s14, s71, 0
    buffer_load_dwordx4 v11, s[52:55], s14 offen sc1 lds
    s_add_u32 m0, s13, 4096
    s_add_u32 s14, s71, 4096
    buffer_load_dwordx4 v11, s[52:55], s14 offen sc1 lds
    s_add_u32 m0, s13, 8192
    s_add_u32 s14, s71, 49152
    buffer_load_dwordx4 v11, s[52:55], s14 offen sc1 lds
    s_add_u32 m0, s13, 12288
    s_add_u32 s14, s71, 53248
    buffer_load_dwordx4 v11, s[52:55], s14 offen sc1 lds
    s_add_u32 s71, s71, 196608
    s_cmp_ge_u32 s71, s63
    s_cselect_b32 s12, 1572864, 0
    s_sub_u32 s71, s71, s12
    s_add_u32 m0, s13, 131072
    s_add_u32 s14, s70, 0
    buffer_load_dwordx4 v12, s[36:39], s14 offen  lds
    s_add_u32 m0, s13, 135168
    s_add_u32 s14, s70, 20480
    buffer_load_dwordx4 v12, s[36:39], s14 offen  lds
    s_add_u32 m0, s13, 139264
    s_add_u32 s14, s70, 40960
    buffer_load_dwordx4 v12, s[36:39], s14 offen  lds
    s_add_u32 m0, s13, 143360
    s_add_u32 s14, s70, 61440
    buffer_load_dwordx4 v12, s[36:39], s14 offen  lds
    s_add_u32 s70, s70, 163840
    s_cmp_ge_u32 s70, 1310720
    s_cselect_b32 s12, 1310720, 0
    s_sub_u32 s70, s70, s12
    s_waitcnt vmcnt(16)
    s_barrier
    s_add_u32 m0, s13, 16384
    s_add_u32 s14, s71, 0
    buffer_load_dwordx4 v11, s[52:55], s14 offen sc1 lds
    s_add_u32 m0, s13, 20480
    s_add_u32 s14, s71, 4096
    buffer_load_dwordx4 v11, s[52:55], s14 offen sc1 lds
    s_add_u32 m0, s13, 24576
    s_add_u32 s14, s71, 49152
    buffer_load_dwordx4 v11, s[52:55], s14 offen sc1 lds
    s_add_u32 m0, s13, 28672
    s_add_u32 s14, s71, 53248
    buffer_load_dwordx4 v11, s[52:55], s14 offen sc1 lds
    s_add_u32 s71, s71, 196608
    s_cmp_ge_u32 s71, s63
    s_cselect_b32 s12, 1572864, 0
    s_sub_u32 s71, s71, s12
    s_waitcnt vmcnt(16)
    s_barrier
    s_add_u32 m0, s13, 147456
    s_add_u32 s14, s70, 0
    buffer_load_dwordx4 v12, s[36:39], s14 offen  lds
    s_add_u32 m0, s13, 151552
    s_add_u32 s14, s70, 20480
    buffer_load_dwordx4 v12, s[36:39], s14 offen  lds
    s_add_u32 m0, s13, 155648
    s_add_u32 s14, s70, 40960
    buffer_load_dwordx4 v12, s[36:39], s14 offen  lds
    s_add_u32 m0, s13, 159744
    s_add_u32 s14, s70, 61440
    buffer_load_dwordx4 v12, s[36:39], s14 offen  lds
    s_add_u32 s70, s70, 163840
    s_cmp_ge_u32 s70, 1310720
    s_cselect_b32 s12, 1310720, 0
    s_sub_u32 s70, s70, s12
    s_add_u32 m0, s13, 32768
    s_add_u32 s14, s71, 0
    buffer_load_dwordx4 v11, s[52:55], s14 offen sc1 lds
    s_add_u32 m0, s13, 36864
    s_add_u32 s14, s71, 4096
    buffer_load_dwordx4 v11, s[52:55], s14 offen sc1 lds
    s_add_u32 m0, s13, 40960
    s_add_u32 s14, s71, 49152
    buffer_load_dwordx4 v11, s[52:55], s14 offen sc1 lds
    s_add_u32 m0, s13, 45056
    s_add_u32 s14, s71, 53248
    buffer_load_dwordx4 v11, s[52:55], s14 offen sc1 lds
    s_add_u32 s71, s71, 196608
    s_cmp_ge_u32 s71, s63
    s_cselect_b32 s12, 1572864, 0
    s_sub_u32 s71, s71, s12
    s_waitcnt vmcnt(16)
    s_barrier
    s_add_u32 m0, s13, 65536
    s_add_u32 s14, s70, 0
    buffer_load_dwordx4 v12, s[36:39], s14 offen  lds
    s_add_u32 m0, s13, 69632
    s_add_u32 s14, s70, 20480
    buffer_load_dwordx4 v12, s[36:39], s14 offen  lds
    s_add_u32 m0, s13, 73728
    s_add_u32 s14, s70, 40960
    buffer_load_dwordx4 v12, s[36:39], s14 offen  lds
    s_add_u32 m0, s13, 77824
    s_add_u32 s14, s70, 61440
    buffer_load_dwordx4 v12, s[36:39], s14 offen  lds
    s_add_u32 s70, s70, 163840
    s_cmp_ge_u32 s70, 1310720
    s_cselect_b32 s12, 1310720, 0
    s_sub_u32 s70, s70, s12
    s_add_u32 m0, s13, 49152
    s_add_u32 s14, s71, 0
    buffer_load_dwordx4 v11, s[52:55], s14 offen sc1 lds
    s_add_u32 m0, s13, 53248
    s_add_u32 s14, s71, 4096
    buffer_load_dwordx4 v11, s[52:55], s14 offen sc1 lds
    s_add_u32 m0, s13, 57344
    s_add_u32 s14, s71, 49152
    buffer_load_dwordx4 v11, s[52:55], s14 offen sc1 lds
    s_add_u32 m0, s13, 61440
    s_add_u32 s14, s71, 53248
    buffer_load_dwordx4 v11, s[52:55], s14 offen sc1 lds
    s_add_u32 s71, s71, 196608
    s_cmp_ge_u32 s71, s63
    s_cselect_b32 s12, 1572864, 0
    s_sub_u32 s71, s71, s12
    s_waitcnt vmcnt(16)
    s_barrier
    s_getpc_b64 s[22:23]
L_pc3:
    s_lshl_b32 s9, s5, 2
    s_add_u32 s9, s9, s11
    s_and_b32 s9, s9, 63
    s_lshl_b32 s9, s9, 6
    s_min_u32 s9, s9, L_end-L_tail2
    s_add_u32 s9, s9, L_tail2-L_pc3
    s_add_u32 s22, s22, s9
    s_addc_u32 s23, s23, 0
    s_load_dword s24, s[22:23], 0x0
    s_add_u32 m0, s13, 81920
    s_add_u32 s14, s70, 0
    buffer_load_dwordx4 v12, s[36:39], s14 offen  lds
    s_add_u32 m0, s13, 86016
    s_add_u32 s14, s70, 20480
    buffer_load_dwordx4 v12, s[36:39], s14 offen  lds
    s_add_u32 m0, s13, 90112
    s_add_u32 s14, s70, 40960
    buffer_load_dwordx4 v12, s[36:39], s14 offen  lds
    s_add_u32 m0, s13, 94208
    s_add_u32 s14, s70, 61440
    buffer_load_dwordx4 v12, s[36:39], s14 offen  lds
    s_add_u32 s70, s70, 163840
    s_cmp_ge_u32 s70, 1310720
    s_cselect_b32 s12, 1310720, 0
    s_sub_u32 s70, s70, s12
    s_add_u32 m0, s13, 0
    s_add_u32 s14, s71, 0
    buffer_load_dwordx4 v11, s[52:55], s14 offen sc1 lds
    s_add_u32 m0, s13, 4096
    s_add_u32 s14, s71, 4096
    buffer_load_dwordx4 v11, s[52:55], s14 offen sc1 lds
    s_add_u32 m0, s13, 8192
    s_add_u32 s14, s71, 49152
    buffer_load_dwordx4 v11, s[52:55], s14 offen sc1 lds
    s_add_u32 m0, s13, 12288
    s_add_u32 s14, s71, 53248
    buffer_load_dwordx4 v11, s[52:55], s14 offen sc1 lds
    s_add_u32 s71, s71, 196608
    s_cmp_ge_u32 s71, s63
    s_cselect_b32 s12, 1572864, 0
    s_sub_u32 s71, s71, s12
    s_waitcnt vmcnt(16)
    s_barrier
    s_add_u32 m0, s13, 98304
    s_add_u32 s14, s70, 0
    buffer_load_dwordx4 v12, s[36:39], s14 offen  lds
    s_add_u32 m0, s13, 102400
    s_add_u32 s14, s70, 20480
    buffer_load_dwordx4 v12, s[36:39], s14 offen  lds
    s_add_u32 m0, s13, 106496
    s_add_u32 s14, s70, 40960
    buffer_load_dwordx4 v12, s[36:39], s14 offen  lds
    s_add_u32 m0, s13, 110592
    s_add_u32 s14, s70, 61440
    buffer_load_dwordx4 v12, s[36:39], s14 offen  lds
    s_add_u32 s70, s70, 163840
    s_cmp_ge_u32 s70, 1310720
    s_cselect_b32 s12, 1310720, 0
    s_sub_u32 s70, s70, s12
    s_add_u32 m0, s13, 16384
    s_add_u32 s14, s71, 0
    buffer_load_dwordx4 v11, s[52:55], s14 offen sc1 lds
    s_add_u32 m0, s13, 20480
    s_add_u32 s14, s71, 4096
    buffer_load_dwordx4 v11, s[52:55], s14 offen sc1 lds
    s_add_u32 m0, s13, 24576
    s_add_u32 s14, s71, 49152
    buffer_load_dwordx4 v11, s[52:55], s14 offen sc1 lds
    s_add_u32 m0, s13, 28672
    s_add_u32 s14, s71, 53248
    buffer_load_dwordx4 v11, s[52:55], s14 offen sc1 lds
    s_add_u32 s71, s71, 196608
    s_cmp_ge_u32 s71, s63
    s_cselect_b32 s12, 1572864, 0
    s_sub_u32 s71, s71, s12
    s_waitcnt vmcnt(16)
    s_barrier
    s_add_u32 m0, s13, 114688
    s_add_u32 s14, s70, 0
    buffer_load_dwordx4 v12, s[36:39], s14 offen  lds
    s_add_u32 m0, s13, 118784
    s_add_u32 s14, s70, 20480
    buffer_load_dwordx4 v12, s[36:39], s14 offen  lds
    s_add_u32 m0, s13, 122880
    s_add_u32 s14, s70, 40960
    buffer_load_dwordx4 v12, s[36:39], s14 offen  lds
    s_add_u32 m0, s13, 126976
    s_add_u32 s14, s70, 61440
    buffer_load_dwordx4 v12, s[36:39], s14 offen  lds
    s_add_u32 s70, s70, 163840
    s_cmp_ge_u32 s70, 1310720
    s_cselect_b32 s12, 1310720, 0
    s_sub_u32 s70, s70, s12
    s_add_u32 m0, s13, 32768
    s_add_u32 s14, s71, 0
    buffer_load_dwordx4 v11, s[52:55], s14 offen sc1 lds
    s_add_u32 m0, s13, 36864
    s_add_u32 s14, s71, 4096
    buffer_load_dwordx4 v11, s[52:55], s14 offen sc1 lds
    s_add_u32 m0, s13, 40960
    s_add_u32 s14, s71, 49152
    buffer_load_dwordx4 v11, s[52:55], s14 offen sc1 lds
    s_add_u32 m0, s13, 45056
    s_add_u32 s14, s71, 53248
    buffer_load_dwordx4 v11, s[52:55], s14 offen sc1 lds
    s_add_u32 s71, s71, 196608
    s_cmp_ge_u32 s71, s63
    s_cselect_b32 s12, 1572864, 0
    s_sub_u32 s71, s71, s12
    s_waitcnt vmcnt(16)
    s_barrier
    s_add_u32 m0, s13, 131072
    s_add_u32 s14, s70, 0
    buffer_load_dwordx4 v12, s[36:39], s14 offen  lds
    s_add_u32 m0, s13, 135168
    s_add_u32 s14, s70, 20480
    buffer_load_dwordx4 v12, s[36:39], s14 offen  lds
    s_add_u32 m0, s13, 139264
    s_add_u32 s14, s70, 40960
    buffer_load_dwordx4 v12, s[36:39], s14 offen  lds
    s_add_u32 m0, s13, 143360
    s_add_u32 s14, s70, 61440
    buffer_load_dwordx4 v12, s[36:39], s14 offen  lds
    s_add_u32 s70, s70, 163840
    s_cmp_ge_u32 s70, 1310720
    s_cselect_b32 s12, 1310720, 0
    s_sub_u32 s70, s70, s12
    s_add_u32 m0, s13, 49152
    s_add_u32 s14, s71, 0
    buffer_load_dwordx4 v11, s[52:55], s14 offen sc1 lds
    s_add_u32 m0, s13, 53248
    s_add_u32 s14, s71, 4096
    buffer_load_dwordx4 v11, s[52:55], s14 offen sc1 lds
    s_add_u32 m0, s13, 57344
    s_add_u32 s14, s71, 49152
    buffer_load_dwordx4 v11, s[52:55], s14 offen sc1 lds
    s_add_u32 m0, s13, 61440
    s_add_u32 s14, s71, 53248
    buffer_load_dwordx4 v11, s[52:55], s14 offen sc1 lds
    s_add_u32 s71, s71, 196608
    s_cmp_ge_u32 s71, s63
    s_cselect_b32 s12, 1572864, 0
    s_sub_u32 s71, s71, s12
    s_waitcnt vmcnt(16)
    s_barrier
    s_waitcnt vmcnt(8)
    s_barrier
    s_waitcnt vmcnt(0)
    s_barrier
    s_endpgm
L_ld_idle:
    s_barrier
    s_endpgm
L_compute:
    v_bfe_u32 v5, v2, 2, 2
    v_and_b32 v6, 3, v2
    v_and_b32 v7, 1, v3
    v_lshl_add_u32 v7, v7, 2, v5
    v_lshlrev_b32 v7, 1, v7
    v_lshrrev_b32 v8, 1, v6
    v_xor_b32 v7, v7, v8
    v_lshlrev_b32 v7, 4, v7
    v_and_b32 v8, 1, v6
    v_lshl_add_u32 v7, v8, 3, v7
    v_lshl_add_u32 v8, v3, 3, v5
    v_lshl_add_u32 v8, v8, 8, v7
    v_add_u32 v8, 90112, v8
    v_xor_b32 v240, 0, v8
    v_xor_b32 v241, 32, v8
    v_xor_b32 v242, 64, v8
    v_xor_b32 v243, 96, v8
    v_xor_b32 v244, 128, v8
    v_xor_b32 v245, 160, v8
    v_xor_b32 v246, 192, v8
    v_xor_b32 v247, 224, v8
    v_lshrrev_b32 v8, 1, v4
    v_xor_b32 v8, v8, v3
    v_lshlrev_b32 v8, 4, v8
    v_lshl_add_u32 v8, v4, 7, v8
    s_mul_i32 s13, s3, 6144
    s_add_u32 s13, s13, 24576
    v_add_u32 v248, s13, v8
    v_xor_b32 v249, 64, v248
    s_cmp_lt_u32 s3, 2
    s_mov_b32 s13, 139264
    s_mov_b32 s14, 0
    s_cselect_b32 s13, 114688, s13
    s_cselect_b32 s14, 49152, s14
    v_lshrrev_b32 v8, 1, v3
    v_xor_b32 v8, v8, v4
    v_lshlrev_b32 v8, 4, v8
    v_lshl_add_u32 v8, v4, 8, v8
    v_and_b32 v9, 1, v3
    v_lshl_add_u32 v8, v9, 3, v8
    v_add_u32 v10, s13, v8
    v_lshl_add_u32 v8, v3, 2, v5
    v_lshl_add_u32 v6, v8, 8, v7
    v_add_u32 v11, s14, v6
    v_lshlrev_b32 v9, 4, v2
    v_mov_b32 v12, 0x3f803f80
    v_mov_b32 v13, 0x3f803f80
    v_mov_b32 v14, 0x3f803f80
    v_mov_b32 v15, 0x3f803f80
    v_mov_b32 v16, 0
    v_mov_b32 v17, 0
    v_mov_b32 v18, 0
    v_mov_b32 v19, 0
    v_mov_b32 v20, 0
    v_mov_b32 v21, 0
    v_mov_b32 v22, 0
    v_mov_b32 v23, 0
    v_mov_b32 v24, 0
    v_mov_b32 v25, 0
    v_mov_b32 v26, 0
    v_mov_b32 v27, 0
    v_mov_b32 v28, 0
    v_mov_b32 v29, 0
    v_mov_b32 v30, 0
    v_mov_b32 v31, 0
    v_mov_b32 v32, 0
    v_mov_b32 v33, 0
    v_mov_b32 v34, 0
    v_mov_b32 v35, 0
    v_mov_b32 v36, 0
    v_mov_b32 v37, 0
    v_mov_b32 v38, 0
    v_mov_b32 v39, 0
    v_mov_b32 v40, 0
    v_mov_b32 v41, 0
    v_mov_b32 v42, 0
    v_mov_b32 v43, 0
    v_mov_b32 v44, 0
    v_mov_b32 v45, 0
    v_mov_b32 v46, 0
    v_mov_b32 v47, 0
    v_mov_b32 v48, 0
    v_mov_b32 v49, 0
    v_mov_b32 v50, 0
    v_mov_b32 v51, 0
    v_mov_b32 v52, 0
    v_mov_b32 v53, 0
    v_mov_b32 v54, 0
    v_mov_b32 v55, 0
    v_mov_b32 v56, 0
    v_mov_b32 v57, 0
    v_mov_b32 v58, 0
    v_mov_b32 v59, 0
    v_mov_b32 v60, 0
    v_mov_b32 v61, 0
    v_mov_b32 v62, 0
    v_mov_b32 v63, 0
    v_mov_b32 v64, 0
    v_mov_b32 v65, 0
    v_mov_b32 v66, 0
    v_mov_b32 v67, 0
    v_mov_b32 v68, 0
    v_mov_b32 v69, 0
    v_mov_b32 v70, 0
    v_mov_b32 v71, 0
    v_mov_b32 v72, 0
    v_mov_b32 v73, 0
    v_mov_b32 v74, 0
    v_mov_b32 v75, 0
    v_mov_b32 v76, 0
    v_mov_b32 v77, 0
    v_mov_b32 v78, 0
    v_mov_b32 v79, 0
    v_mov_b32 v80, 0
    v_mov_b32 v81, 0
    v_mov_b32 v82, 0
    v_mov_b32 v83, 0
    v_mov_b32 v84, 0
    v_mov_b32 v85, 0
    v_mov_b32 v86, 0
    v_mov_b32 v87, 0
    v_mov_b32 v88, 0
    v_mov_b32 v89, 0
    v_mov_b32 v90, 0
    v_mov_b32 v91, 0
    v_mov_b32 v92, 0
    v_mov_b32 v93, 0
    v_mov_b32 v94, 0
    v_mov_b32 v95, 0
    v_mov_b32 v96, 0
    v_mov_b32 v97, 0
    v_mov_b32 v98, 0
    v_mov_b32 v99, 0
    v_mov_b32 v100, 0
    v_mov_b32 v101, 0
    v_mov_b32 v102, 0
    v_mov_b32 v103, 0
    v_mov_b32 v104, 0
    v_mov_b32 v105, 0
    v_mov_b32 v106, 0
    v_mov_b32 v107, 0
    v_mov_b32 v108, 0
    v_mov_b32 v109, 0
    v_mov_b32 v110, 0
    v_mov_b32 v111, 0
    s_mul_i32 s62, s66, 192
    s_mul_i32 s14, s8, 12
    s_add_u32 s62, s62, s14
    s_mul_i32 s14, s3, 3
    s_add_u32 s62, s62, s14
    s_lshl_b32 s62, s62, 10
    s_mul_i32 s68, s4, 1601536
    s_add_u32 s62, s62, s68
    s_add_u32 s62, s62, 4096
    s_mov_b32 s63, 0x3e0293ee
    s_mov_b32 s50, s63
    s_mov_b32 s51, s63
    s_lshl_b32 s69, s8, 2
    s_add_u32 s69, s69, s3
    s_lshl_b32 s69, s69, 3
    s_add_u32 s69, s69, s66
    s_lshl_b32 s69, s69, 3
    s_add_u32 s69, s69, s68
    s_add_u32 s69, s69, 1576960
    s_waitcnt lgkmcnt(0)
    s_mov_b32 s52, s34
    s_and_b32 s53, s35, 0xffff
    s_mov_b32 s54, 50331648
    s_mov_b32 s55, 0x20000
    s_mov_b32 s98, s96
    s_add_u32 s99, s97, 1
    s_mov_b64 s[34:35], s[32:33]
    s_load_dwordx2 s[20:21], s[0:1], 80
    s_waitcnt lgkmcnt(0)
    s_mov_b32 s44, s20
    s_and_b32 s45, s21, 0xffff
    s_mov_b32 s46, 1966080
    s_mov_b32 s47, 0x20000
    s_mul_i32 s66, s5, 52
    s_lshr_b32 s66, s66, 8
    s_mul_i32 s67, s66, 5
    s_sub_u32 s67, s5, s67
    s_and_b32 s10, s4, 3
    s_and_b32 s12, s3, 1
    s_lshl_b32 s12, s12, 2
    s_add_u32 s12, s12, s10
    s_mul_i32 s61, s6, 32
    s_add_u32 s61, s61, s5
    s_mul_i32 s61, s61, 102400
    s_add_u32 s61, s61, 16777216
    s_xor_b32 s36, s10, 1
    s_lshl_b32 s36, s36, 2
    s_add_u32 s36, s36, s3
    s_mul_i32 s36, s36, 6144
    s_add_u32 s36, s36, s61
    s_add_u32 s36, s36, 1024
    s_xor_b32 s37, s10, 2
    s_lshl_b32 s37, s37, 2
    s_add_u32 s37, s37, s3
    s_mul_i32 s37, s37, 6144
    s_add_u32 s37, s37, s61
    s_add_u32 s37, s37, 3072
    s_xor_b32 s38, s10, 3
    s_lshl_b32 s38, s38, 2
    s_add_u32 s38, s38, s3
    s_mul_i32 s38, s38, 6144
    s_add_u32 s38, s38, s61
    s_add_u32 s38, s38, 5120
    s_xor_b32 s39, s10, 0
    s_lshl_b32 s39, s39, 2
    s_add_u32 s39, s39, s3
    s_mul_i32 s39, s39, 6144
    s_add_u32 s39, s39, s61
    s_add_u32 s39, s39, 1024
    s_lshl_b32 s40, s3, 9
    s_add_u32 s40, s40, s61
    s_add_u32 s40, s40, 99328
    s_lshl_b32 s41, s66, 3
    s_add_u32 s41, s41, s12
    s_mul_i32 s41, s41, 40960
    s_mul_i32 s13, s6, 1280
    s_add_u32 s41, s41, s13
    s_lshl_b32 s13, s67, 8
    s_add_u32 s41, s41, s13
    s_lshr_b32 s13, s3, 1
    s_lshl_b32 s13, s13, 7
    s_add_u32 s41, s41, s13
    s_lshl_b32 s42, s10, 7
    s_add_u32 s42, s42, s40
    s_add_u32 s16, s62, 0
    s_add_u32 s17, s62, 49152
    s_add_u32 s18, s62, 98304
    s_add_u32 s19, s62, 147456
    s_add_u32 s43, s39, 4096
    s_add_u32 s48, s39, 8192
    v_mov_b32 v250, 0
    s_mov_b64 exec, 1
    buffer_load_dword v251, v250, s[52:55], s69 offen sc1
    buffer_load_dword v251, v250, s[52:55], s69 offen offset:1024 sc1
    buffer_load_dword v251, v250, s[52:55], s42 offen sc1
    s_mov_b64 exec, -1
    s_mov_b32 s14, 1
    s_mov_b32 s15, 0
    s_barrier
    ds_read_b128 v[176:179], v248 offset:0
    ds_read_b128 v[180:183], v248 offset:2048
    ds_read_b128 v[184:187], v248 offset:4096
    ds_read_b64_tr_b16 v[112:113], v240 offset:0
    ds_read_b64_tr_b16 v[114:115], v240 offset:1024
    ds_read_b64_tr_b16 v[116:117], v241 offset:0
    ds_read_b64_tr_b16 v[118:119], v241 offset:1024
    ds_read_b64_tr_b16 v[120:121], v242 offset:0
    ds_read_b64_tr_b16 v[122:123], v242 offset:1024
    ds_read_b64_tr_b16 v[124:125], v243 offset:0
    ds_read_b64_tr_b16 v[126:127], v243 offset:1024
    ds_read_b64_tr_b16 v[128:129], v244 offset:0
    ds_read_b64_tr_b16 v[130:131], v244 offset:1024
    ds_read_b64_tr_b16 v[132:133], v245 offset:0
    ds_read_b64_tr_b16 v[134:135], v245 offset:1024
    ds_read_b64_tr_b16 v[136:137], v246 offset:0
    ds_read_b64_tr_b16 v[138:139], v246 offset:1024
    ds_read_b64_tr_b16 v[140:141], v247 offset:0
    ds_read_b64_tr_b16 v[142:143], v247 offset:1024
L_loop:
    ds_read_b128 v[188:191], v249 offset:0
    ds_read_b128 v[192:195], v249 offset:2048
    ds_read_b128 v[196:199], v249 offset:4096
    ds_read_b64_tr_b16 v[144:145], v240 offset:8192
    ds_read_b64_tr_b16 v[146:147], v240 offset:9216
    ds_read_b64_tr_b16 v[148:149], v241 offset:8192
    ds_read_b64_tr_b16 v[150:151], v241 offset:9216
    ds_read_b64_tr_b16 v[152:153], v242 offset:8192
    ds_read_b64_tr_b16 v[154:155], v242 offset:9216
    ds_read_b64_tr_b16 v[156:157], v243 offset:8192
    ds_read_b64_tr_b16 v[158:159], v243 offset:9216
    ds_read_b64_tr_b16 v[160:161], v244 offset:8192
    ds_read_b64_tr_b16 v[162:163], v244 offset:9216
    ds_read_b64_tr_b16 v[164:165], v245 offset:8192
    ds_read_b64_tr_b16 v[166:167], v245 offset:9216
    ds_read_b64_tr_b16 v[168:169], v246 offset:8192
    ds_read_b64_tr_b16 v[170:171], v246 offset:9216
    ds_read_b64_tr_b16 v[172:173], v247 offset:8192
    ds_read_b64_tr_b16 v[174:175], v247 offset:9216
    s_add_u32 s14, s14, 1
    s_cmp_eq_u32 s14, 3
    s_cselect_b32 s61, -2, 1
    s_cselect_b32 s14, 0, s14
    s_mul_i32 s64, s61, 16384
    s_mul_i32 s65, s61, 24576
    s_add_u32 s15, s15, 1
    s_cmp_eq_u32 s15, 10
    s_waitcnt lgkmcnt(8)
    v_mfma_f32_16x16x32_bf16 v[16:19], v[112:115], v[176:179], v[16:19]
    v_mfma_f32_16x16x32_bf16 v[20:23], v[112:115], v[180:183], v[20:23]
    v_mfma_f32_16x16x32_bf16 v[24:27], v[112:115], v[184:187], v[24:27]
    v_mfma_f32_16x16x32_bf16 v[36:39], v[116:119], v[184:187], v[36:39]
    v_mfma_f32_16x16x32_bf16 v[32:35], v[116:119], v[180:183], v[32:35]
    v_mfma_f32_16x16x32_bf16 v[28:31], v[116:119], v[176:179], v[28:31]
    v_mfma_f32_16x16x32_bf16 v[40:43], v[120:123], v[176:179], v[40:43]
    v_mfma_f32_16x16x32_bf16 v[44:47], v[120:123], v[180:183], v[44:47]
    v_mfma_f32_16x16x32_bf16 v[48:51], v[120:123], v[184:187], v[48:51]
    v_mfma_f32_16x16x32_bf16 v[60:63], v[124:127], v[184:187], v[60:63]
    v_mfma_f32_16x16x32_bf16 v[56:59], v[124:127], v[180:183], v[56:59]
    v_mfma_f32_16x16x32_bf16 v[52:55], v[124:127], v[176:179], v[52:55]
    v_mfma_f32_16x16x32_bf16 v[64:67], v[128:131], v[176:179], v[64:67]
    v_mfma_f32_16x16x32_bf16 v[68:71], v[128:131], v[180:183], v[68:71]
    v_mfma_f32_16x16x32_bf16 v[72:75], v[128:131], v[184:187], v[72:75]
    v_mfma_f32_16x16x32_bf16 v[84:87], v[132:135], v[184:187], v[84:87]
    v_mfma_f32_16x16x32_bf16 v[80:83], v[132:135], v[180:183], v[80:83]
    v_mfma_f32_16x16x32_bf16 v[76:79], v[132:135], v[176:179], v[76:79]
    v_mfma_f32_16x16x32_bf16 v[88:91], v[136:139], v[176:179], v[88:91]
    v_mfma_f32_16x16x32_bf16 v[92:95], v[136:139], v[180:183], v[92:95]
    v_mfma_f32_16x16x32_bf16 v[96:99], v[136:139], v[184:187], v[96:99]
    v_mfma_f32_16x16x32_bf16 v[108:111], v[140:143], v[184:187], v[108:111]
    v_mfma_f32_16x16x32_bf16 v[104:107], v[140:143], v[180:183], v[104:107]
    v_mfma_f32_16x16x32_bf16 v[100:103], v[140:143], v[176:179], v[100:103]
    s_cbranch_scc1 L_tail
    v_mfma_f32_16x16x32_bf16 v[16:19], v[144:147], v[188:191], v[16:19]
    v_mfma_f32_16x16x32_bf16 v[20:23], v[144:147], v[192:195], v[20:23]
    v_mfma_f32_16x16x32_bf16 v[24:27], v[144:147], v[196:199], v[24:27]
    v_mfma_f32_16x16x32_bf16 v[36:39], v[148:151], v[196:199], v[36:39]
    v_mfma_f32_16x16x32_bf16 v[32:35], v[148:151], v[192:195], v[32:35]
    v_mfma_f32_16x16x32_bf16 v[28:31], v[148:151], v[188:191], v[28:31]
    v_mfma_f32_16x16x32_bf16 v[40:43], v[152:155], v[188:191], v[40:43]
    v_mfma_f32_16x16x32_bf16 v[44:47], v[152:155], v[192:195], v[44:47]
    v_mfma_f32_16x16x32_bf16 v[48:51], v[152:155], v[196:199], v[48:51]
    v_mfma_f32_16x16x32_bf16 v[60:63], v[156:159], v[196:199], v[60:63]
    v_mfma_f32_16x16x32_bf16 v[56:59], v[156:159], v[192:195], v[56:59]
    v_mfma_f32_16x16x32_bf16 v[52:55], v[156:159], v[188:191], v[52:55]
    s_waitcnt lgkmcnt(6)
    v_mfma_f32_16x16x32_bf16 v[64:67], v[160:163], v[188:191], v[64:67]
    v_mfma_f32_16x16x32_bf16 v[68:71], v[160:163], v[192:195], v[68:71]
    v_mfma_f32_16x16x32_bf16 v[72:75], v[160:163], v[196:199], v[72:75]
    s_waitcnt lgkmcnt(4)
    v_mfma_f32_16x16x32_bf16 v[84:87], v[164:167], v[196:199], v[84:87]
    v_mfma_f32_16x16x32_bf16 v[80:83], v[164:167], v[192:195], v[80:83]
    v_mfma_f32_16x16x32_bf16 v[76:79], v[164:167], v[188:191], v[76:79]
    s_waitcnt lgkmcnt(2)
    v_mfma_f32_16x16x32_bf16 v[88:91], v[168:171], v[188:191], v[88:91]
    v_mfma_f32_16x16x32_bf16 v[92:95], v[168:171], v[192:195], v[92:95]
    v_mfma_f32_16x16x32_bf16 v[96:99], v[168:171], v[196:199], v[96:99]
    s_waitcnt lgkmcnt(0)
    v_mfma_f32_16x16x32_bf16 v[108:111], v[172:175], v[196:199], v[108:111]
    v_mfma_f32_16x16x32_bf16 v[104:107], v[172:175], v[192:195], v[104:107]
    v_mfma_f32_16x16x32_bf16 v[100:103], v[172:175], v[188:191], v[100:103]
    v_add_u32 v248, s65, v248
    v_add_u32 v249, s65, v249
    v_add_u32 v240, s64, v240
    v_add_u32 v241, s64, v241
    v_add_u32 v242, s64, v242
    v_add_u32 v243, s64, v243
    v_add_u32 v244, s64, v244
    v_add_u32 v245, s64, v245
    v_add_u32 v246, s64, v246
    v_add_u32 v247, s64, v247
    s_barrier
    ds_read_b128 v[176:179], v248 offset:0
    ds_read_b128 v[180:183], v248 offset:2048
    ds_read_b128 v[184:187], v248 offset:4096
    ds_read_b64_tr_b16 v[112:113], v240 offset:0
    ds_read_b64_tr_b16 v[114:115], v240 offset:1024
    ds_read_b64_tr_b16 v[116:117], v241 offset:0
    ds_read_b64_tr_b16 v[118:119], v241 offset:1024
    ds_read_b64_tr_b16 v[120:121], v242 offset:0
    ds_read_b64_tr_b16 v[122:123], v242 offset:1024
    ds_read_b64_tr_b16 v[124:125], v243 offset:0
    ds_read_b64_tr_b16 v[126:127], v243 offset:1024
    ds_read_b64_tr_b16 v[128:129], v244 offset:0
    ds_read_b64_tr_b16 v[130:131], v244 offset:1024
    ds_read_b64_tr_b16 v[132:133], v245 offset:0
    ds_read_b64_tr_b16 v[134:135], v245 offset:1024
    ds_read_b64_tr_b16 v[136:137], v246 offset:0
    ds_read_b64_tr_b16 v[138:139], v246 offset:1024
    ds_read_b64_tr_b16 v[140:141], v247 offset:0
    ds_read_b64_tr_b16 v[142:143], v247 offset:1024
    s_branch L_loop
L_tail:
    s_memrealtime s[70:71]
    v_mfma_f32_16x16x32_bf16 v[16:19], v[144:147], v[188:191], v[16:19]
    v_xor_b32 v240, 0, v10
    v_xor_b32 v241, 32, v10
    v_mfma_f32_16x16x32_bf16 v[20:23], v[144:147], v[192:195], v[20:23]
    v_xor_b32 v242, 64, v10
    v_xor_b32 v243, 96, v10
    v_mfma_f32_16x16x32_bf16 v[24:27], v[144:147], v[196:199], v[24:27]
    v_xor_b32 v244, 128, v10
    v_xor_b32 v245, 160, v10
    v_mfma_f32_16x16x32_bf16 v[36:39], v[148:151], v[196:199], v[36:39]
    v_xor_b32 v246, 192, v10
    v_xor_b32 v247, 224, v10
    v_mfma_f32_16x16x32_bf16 v[32:35], v[148:151], v[192:195], v[32:35]
    s_waitcnt lgkmcnt(0)
    v_mov_b32 v254, s70
    v_mov_b32 v255, s71
    v_mov_b32 v253, 0
    v_mfma_f32_16x16x32_bf16 v[28:31], v[148:151], v[188:191], v[28:31]
    ds_read_b64 v[112:113], v240 offset:0
    ds_read_b64 v[114:115], v241 offset:0
    v_mfma_f32_16x16x32_bf16 v[40:43], v[152:155], v[188:191], v[40:43]
    ds_read_b64 v[116:117], v242 offset:0
    ds_read_b64 v[118:119], v243 offset:0
    v_mfma_f32_16x16x32_bf16 v[44:47], v[152:155], v[192:195], v[44:47]
    ds_read_b64 v[120:121], v244 offset:0
    ds_read_b64 v[122:123], v245 offset:0
    v_mfma_f32_16x16x32_bf16 v[48:51], v[152:155], v[196:199], v[48:51]
    ds_read_b64 v[124:125], v246 offset:0
    ds_read_b64 v[126:127], v247 offset:0
    v_mfma_f32_16x16x32_bf16 v[60:63], v[156:159], v[196:199], v[60:63]
    ds_read_b64 v[128:129], v240 offset:4096
    ds_read_b64 v[130:131], v241 offset:4096
    v_mfma_f32_16x16x32_bf16 v[56:59], v[156:159], v[192:195], v[56:59]
    ds_read_b64 v[132:133], v242 offset:4096
    ds_read_b64 v[134:135], v243 offset:4096
    v_mfma_f32_16x16x32_bf16 v[52:55], v[156:159], v[188:191], v[52:55]
    ds_read_b64 v[136:137], v244 offset:4096
    ds_read_b64 v[138:139], v245 offset:4096
    v_mfma_f32_16x16x32_bf16 v[64:67], v[160:163], v[188:191], v[64:67]
    ds_read_b64 v[140:141], v246 offset:4096
    ds_read_b64 v[142:143], v247 offset:4096
    v_mfma_f32_16x16x32_bf16 v[68:71], v[160:163], v[192:195], v[68:71]
    ds_read_b64 v[176:177], v240 offset:8192
    ds_read_b64 v[178:179], v241 offset:8192
    v_mfma_f32_16x16x32_bf16 v[72:75], v[160:163], v[196:199], v[72:75]
    ds_read_b64 v[180:181], v242 offset:8192
    ds_read_b64 v[182:183], v243 offset:8192
    v_mfma_f32_16x16x32_bf16 v[84:87], v[164:167], v[196:199], v[84:87]
    ds_read_b64 v[184:185], v244 offset:8192
    ds_read_b64 v[186:187], v245 offset:8192
    v_mfma_f32_16x16x32_bf16 v[80:83], v[164:167], v[192:195], v[80:83]
    ds_read_b64 v[200:201], v246 offset:8192
    ds_read_b64 v[202:203], v247 offset:8192
    v_mfma_f32_16x16x32_bf16 v[76:79], v[164:167], v[188:191], v[76:79]
    ds_read_b64 v[204:205], v240 offset:12288
    ds_read_b64 v[206:207], v241 offset:12288
    v_mfma_f32_16x16x32_bf16 v[88:91], v[168:171], v[188:191], v[88:91]
    ds_read_b64 v[208:209], v242 offset:12288
    ds_read_b64 v[210:211], v243 offset:12288
    v_mfma_f32_16x16x32_bf16 v[92:95], v[168:171], v[192:195], v[92:95]
    ds_read_b64 v[212:213], v244 offset:12288
    ds_read_b64 v[214:215], v245 offset:12288
    v_mfma_f32_16x16x32_bf16 v[96:99], v[168:171], v[196:199], v[96:99]
    ds_read_b64 v[216:217], v246 offset:12288
    ds_read_b64 v[218:219], v247 offset:12288
    v_mfma_f32_16x16x32_bf16 v[108:111], v[172:175], v[196:199], v[108:111]
    ds_read_b64 v[220:221], v240 offset:16384
    ds_read_b64 v[222:223], v241 offset:16384
    v_mfma_f32_16x16x32_bf16 v[104:107], v[172:175], v[192:195], v[104:107]
    ds_read_b64 v[224:225], v242 offset:16384
    ds_read_b64 v[226:227], v243 offset:16384
    v_mfma_f32_16x16x32_bf16 v[100:103], v[172:175], v[188:191], v[100:103]
    ds_read_b64 v[228:229], v244 offset:16384
    ds_read_b64 v[230:231], v245 offset:16384
    ds_read_b64 v[232:233], v246 offset:16384
    ds_read_b64 v[234:235], v247 offset:16384
    ds_read_b64 v[236:237], v240 offset:20480
    ds_read_b64 v[238:239], v241 offset:20480
    ds_read_b64 v[144:145], v242 offset:20480
    ds_read_b64 v[146:147], v243 offset:20480
    ds_read_b64 v[148:149], v244 offset:20480
    ds_read_b64 v[150:151], v245 offset:20480
    ds_read_b64 v[152:153], v246 offset:20480
    ds_read_b64 v[154:155], v247 offset:20480
    v_cvt_pk_bf16_f32 v16, v16, v17
    v_cvt_pk_bf16_f32 v17, v18, v19
    v_cvt_pk_bf16_f32 v18, v28, v29
    v_cvt_pk_bf16_f32 v19, v30, v31
    v_cvt_pk_bf16_f32 v40, v40, v41
    v_cvt_pk_bf16_f32 v41, v42, v43
    v_cvt_pk_bf16_f32 v42, v52, v53
    v_cvt_pk_bf16_f32 v43, v54, v55
    v_cvt_pk_bf16_f32 v64, v64, v65
    v_cvt_pk_bf16_f32 v65, v66, v67
    v_cvt_pk_bf16_f32 v66, v76, v77
    v_cvt_pk_bf16_f32 v67, v78, v79
    v_cvt_pk_bf16_f32 v88, v88, v89
    v_cvt_pk_bf16_f32 v89, v90, v91
    v_cvt_pk_bf16_f32 v90, v100, v101
    v_cvt_pk_bf16_f32 v91, v102, v103
    s_waitcnt lgkmcnt(8)
    v_mfma_f32_16x16x32_bf16 v[156:159], v[112:115], v[16:19], 0
    v_cvt_pk_bf16_f32 v20, v20, v21
    v_cvt_pk_bf16_f32 v21, v22, v23
    v_mfma_f32_16x16x32_bf16 v[160:163], v[128:131], v[16:19], 0
    v_cvt_pk_bf16_f32 v22, v32, v33
    v_cvt_pk_bf16_f32 v23, v34, v35
    v_mfma_f32_16x16x32_bf16 v[164:167], v[176:179], v[16:19], 0
    v_cvt_pk_bf16_f32 v44, v44, v45
    v_cvt_pk_bf16_f32 v45, v46, v47
    v_mfma_f32_16x16x32_bf16 v[168:171], v[204:207], v[16:19], 0
    v_cvt_pk_bf16_f32 v46, v56, v57
    v_cvt_pk_bf16_f32 v47, v58, v59
    v_mfma_f32_16x16x32_bf16 v[172:175], v[220:223], v[16:19], 0
    v_cvt_pk_bf16_f32 v68, v68, v69
    v_cvt_pk_bf16_f32 v69, v70, v71
    s_waitcnt lgkmcnt(6)
    v_mfma_f32_16x16x32_bf16 v[188:191], v[236:239], v[16:19], 0
    v_cvt_pk_bf16_f32 v70, v80, v81
    v_cvt_pk_bf16_f32 v71, v82, v83
    v_mfma_f32_16x16x32_bf16 v[156:159], v[116:119], v[40:43], v[156:159]
    v_cvt_pk_bf16_f32 v92, v92, v93
    v_cvt_pk_bf16_f32 v93, v94, v95
    v_mfma_f32_16x16x32_bf16 v[160:163], v[132:135], v[40:43], v[160:163]
    v_cvt_pk_bf16_f32 v94, v104, v105
    v_cvt_pk_bf16_f32 v95, v106, v107
    v_mfma_f32_16x16x32_bf16 v[164:167], v[180:183], v[40:43], v[164:167]
    v_cvt_pk_bf16_f32 v24, v24, v25
    v_cvt_pk_bf16_f32 v25, v26, v27
    v_mfma_f32_16x16x32_bf16 v[168:171], v[208:211], v[40:43], v[168:171]
    v_cvt_pk_bf16_f32 v26, v36, v37
    v_cvt_pk_bf16_f32 v27, v38, v39
    v_mfma_f32_16x16x32_bf16 v[172:175], v[224:227], v[40:43], v[172:175]
    v_cvt_pk_bf16_f32 v48, v48, v49
    v_cvt_pk_bf16_f32 v49, v50, v51
    s_waitcnt lgkmcnt(4)
    v_mfma_f32_16x16x32_bf16 v[188:191], v[144:147], v[40:43], v[188:191]
    v_cvt_pk_bf16_f32 v50, v60, v61
    v_cvt_pk_bf16_f32 v51, v62, v63
    v_mfma_f32_16x16x32_bf16 v[156:159], v[120:123], v[64:67], v[156:159]
    v_cvt_pk_bf16_f32 v72, v72, v73
    v_cvt_pk_bf16_f32 v73, v74, v75
    v_mfma_f32_16x16x32_bf16 v[160:163], v[136:139], v[64:67], v[160:163]
    v_cvt_pk_bf16_f32 v74, v84, v85
    v_cvt_pk_bf16_f32 v75, v86, v87
    v_mfma_f32_16x16x32_bf16 v[164:167], v[184:187], v[64:67], v[164:167]
    v_cvt_pk_bf16_f32 v96, v96, v97
    v_cvt_pk_bf16_f32 v97, v98, v99
    v_mfma_f32_16x16x32_bf16 v[168:171], v[212:215], v[64:67], v[168:171]
    v_cvt_pk_bf16_f32 v98, v108, v109
    v_cvt_pk_bf16_f32 v99, v110, v111
    v_mfma_f32_16x16x32_bf16 v[172:175], v[228:231], v[64:67], v[172:175]
    s_waitcnt lgkmcnt(2)
    v_mfma_f32_16x16x32_bf16 v[188:191], v[148:151], v[64:67], v[188:191]
    v_mfma_f32_16x16x32_bf16 v[156:159], v[124:127], v[88:91], v[156:159]
    v_mfma_f32_16x16x32_bf16 v[160:163], v[140:143], v[88:91], v[160:163]
    v_mfma_f32_16x16x32_bf16 v[164:167], v[200:203], v[88:91], v[164:167]
    v_mfma_f32_16x16x32_bf16 v[168:171], v[216:219], v[88:91], v[168:171]
    v_mfma_f32_16x16x32_bf16 v[172:175], v[232:235], v[88:91], v[172:175]
    s_waitcnt lgkmcnt(0)
    v_mfma_f32_16x16x32_bf16 v[188:191], v[152:155], v[88:91], v[188:191]
    v_mfma_f32_16x16x32_bf16 v[28:31], v[112:115], v[20:23], 0
    v_mfma_f32_16x16x32_bf16 v[52:55], v[128:131], v[20:23], 0
    v_mfma_f32_16x16x32_bf16 v[76:79], v[176:179], v[20:23], 0
    v_mfma_f32_16x16x32_bf16 v[100:103], v[204:207], v[20:23], 0
    v_mfma_f32_16x16x32_bf16 v[32:35], v[220:223], v[20:23], 0
    v_max3_f32 v250, v156, v157, v158
    v_max3_f32 v249, v159, v160, v161
    v_mfma_f32_16x16x32_bf16 v[56:59], v[236:239], v[20:23], 0
    v_max3_f32 v250, v250, v162, v163
    v_max3_f32 v249, v249, v164, v165
    v_mfma_f32_16x16x32_bf16 v[28:31], v[116:119], v[44:47], v[28:31]
    v_max3_f32 v250, v250, v166, v167
    v_max3_f32 v249, v249, v168, v169
    v_mfma_f32_16x16x32_bf16 v[52:55], v[132:135], v[44:47], v[52:55]
    v_max3_f32 v250, v250, v170, v171
    v_max3_f32 v249, v249, v172, v173
    v_mfma_f32_16x16x32_bf16 v[76:79], v[180:183], v[44:47], v[76:79]
    v_max3_f32 v250, v250, v174, v175
    v_max3_f32 v249, v249, v188, v189
    v_mfma_f32_16x16x32_bf16 v[100:103], v[208:211], v[44:47], v[100:103]
    v_max3_f32 v250, v250, v190, v191
    v_max_f32 v250, v250, v249
    v_mfma_f32_16x16x32_bf16 v[32:35], v[224:227], v[44:47], v[32:35]
    v_mov_b32 v251, v250
    s_nop 1
    v_permlane16_swap_b32 v250, v251
    v_mfma_f32_16x16x32_bf16 v[56:59], v[144:147], v[44:47], v[56:59]
    v_max_f32 v250, v250, v251
    v_mov_b32 v251, v250
    v_mfma_f32_16x16x32_bf16 v[28:31], v[120:123], v[68:71], v[28:31]
    s_nop 0
    v_permlane32_swap_b32 v250, v251
    v_max_f32 v250, v250, v251
    v_mfma_f32_16x16x32_bf16 v[52:55], v[136:139], v[68:71], v[52:55]
    v_mul_f32 v250, s63, v250
    v_fma_f32 v156, v156, s63, -v250
    v_mfma_f32_16x16x32_bf16 v[76:79], v[184:187], v[68:71], v[76:79]
    v_fma_f32 v157, v157, s63, -v250
    v_fma_f32 v158, v158, s63, -v250
    v_mfma_f32_16x16x32_bf16 v[100:103], v[212:215], v[68:71], v[100:103]
    v_fma_f32 v159, v159, s63, -v250
    v_fma_f32 v160, v160, s63, -v250
    v_mfma_f32_16x16x32_bf16 v[32:35], v[228:231], v[68:71], v[32:35]
    v_fma_f32 v161, v161, s63, -v250
    v_fma_f32 v162, v162, s63, -v250
    v_mfma_f32_16x16x32_bf16 v[56:59], v[148:151], v[68:71], v[56:59]
    v_fma_f32 v163, v163, s63, -v250
    v_mfma_f32_16x16x32_bf16 v[28:31], v[124:127], v[92:95], v[28:31]
    v_exp_f32 v156, v156
    v_mfma_f32_16x16x32_bf16 v[52:55], v[140:143], v[92:95], v[52:55]
    v_exp_f32 v157, v157
    v_mfma_f32_16x16x32_bf16 v[76:79], v[200:203], v[92:95], v[76:79]
    v_exp_f32 v158, v158
    v_mfma_f32_16x16x32_bf16 v[100:103], v[216:219], v[92:95], v[100:103]
    v_exp_f32 v159, v159
    v_mfma_f32_16x16x32_bf16 v[32:35], v[232:235], v[92:95], v[32:35]
    v_exp_f32 v160, v160
    v_mfma_f32_16x16x32_bf16 v[56:59], v[152:155], v[92:95], v[56:59]
    v_exp_f32 v161, v161
    v_mfma_f32_16x16x32_bf16 v[80:83], v[112:115], v[24:27], 0
    v_exp_f32 v162, v162
    v_mfma_f32_16x16x32_bf16 v[104:107], v[128:131], v[24:27], 0
    v_exp_f32 v163, v163
    v_mfma_f32_16x16x32_bf16 v[36:39], v[176:179], v[24:27], 0
    v_cvt_pk_bf16_f32 v156, v156, v157
    v_cvt_pk_bf16_f32 v157, v158, v159
    v_mfma_f32_16x16x32_bf16 v[60:63], v[204:207], v[24:27], 0
    v_cvt_pk_bf16_f32 v158, v160, v161
    v_cvt_pk_bf16_f32 v159, v162, v163
    v_mfma_f32_16x16x32_bf16 v[84:87], v[220:223], v[24:27], 0
    v_fma_f32 v164, v164, s63, -v250
    v_fma_f32 v165, v165, s63, -v250
    v_mfma_f32_16x16x32_bf16 v[108:111], v[236:239], v[24:27], 0
    v_fma_f32 v166, v166, s63, -v250
    v_fma_f32 v167, v167, s63, -v250
    v_mfma_f32_16x16x32_bf16 v[80:83], v[116:119], v[48:51], v[80:83]
    v_fma_f32 v168, v168, s63, -v250
    v_fma_f32 v169, v169, s63, -v250
    v_mfma_f32_16x16x32_bf16 v[104:107], v[132:135], v[48:51], v[104:107]
    v_fma_f32 v170, v170, s63, -v250
    v_fma_f32 v171, v171, s63, -v250
    v_mfma_f32_16x16x32_bf16 v[36:39], v[180:183], v[48:51], v[36:39]
    v_exp_f32 v164, v164
    v_mfma_f32_16x16x32_bf16 v[60:63], v[208:211], v[48:51], v[60:63]
    v_exp_f32 v165, v165
    v_mfma_f32_16x16x32_bf16 v[84:87], v[224:227], v[48:51], v[84:87]
    v_exp_f32 v166, v166
    v_mfma_f32_16x16x32_bf16 v[108:111], v[144:147], v[48:51], v[108:111]
    v_exp_f32 v167, v167
    v_mfma_f32_16x16x32_bf16 v[80:83], v[120:123], v[72:75], v[80:83]
    v_exp_f32 v168, v168
    v_mfma_f32_16x16x32_bf16 v[104:107], v[136:139], v[72:75], v[104:107]
    v_exp_f32 v169, v169
    v_mfma_f32_16x16x32_bf16 v[36:39], v[184:187], v[72:75], v[36:39]
    v_exp_f32 v170, v170
    v_mfma_f32_16x16x32_bf16 v[60:63], v[212:215], v[72:75], v[60:63]
    v_exp_f32 v171, v171
    v_mfma_f32_16x16x32_bf16 v[84:87], v[228:231], v[72:75], v[84:87]
    v_cvt_pk_bf16_f32 v164, v164, v165
    v_cvt_pk_bf16_f32 v165, v166, v167
    v_mfma_f32_16x16x32_bf16 v[108:111], v[148:151], v[72:75], v[108:111]
    v_cvt_pk_bf16_f32 v166, v168, v169
    v_cvt_pk_bf16_f32 v167, v170, v171
    v_mfma_f32_16x16x32_bf16 v[80:83], v[124:127], v[96:99], v[80:83]
    v_fma_f32 v172, v172, s63, -v250
    v_fma_f32 v173, v173, s63, -v250
    v_mfma_f32_16x16x32_bf16 v[104:107], v[140:143], v[96:99], v[104:107]
    v_fma_f32 v174, v174, s63, -v250
    v_fma_f32 v175, v175, s63, -v250
    v_mfma_f32_16x16x32_bf16 v[36:39], v[200:203], v[96:99], v[36:39]
    v_fma_f32 v188, v188, s63, -v250
    v_fma_f32 v189, v189, s63, -v250
    v_mfma_f32_16x16x32_bf16 v[60:63], v[216:219], v[96:99], v[60:63]
    v_fma_f32 v190, v190, s63, -v250
    v_fma_f32 v191, v191, s63, -v250
    v_mfma_f32_16x16x32_bf16 v[84:87], v[232:235], v[96:99], v[84:87]
    v_exp_f32 v172, v172
    v_mfma_f32_16x16x32_bf16 v[108:111], v[152:155], v[96:99], v[108:111]
    v_exp_f32 v173, v173
    v_exp_f32 v174, v174
    v_exp_f32 v175, v175
    v_exp_f32 v188, v188
    v_exp_f32 v189, v189
    v_exp_f32 v190, v190
    v_exp_f32 v191, v191
    v_cvt_pk_bf16_f32 v172, v172, v173
    v_cvt_pk_bf16_f32 v173, v174, v175
    v_cvt_pk_bf16_f32 v174, v188, v189
    v_cvt_pk_bf16_f32 v175, v190, v191
    v_xor_b32 v240, 0, v11
    v_xor_b32 v241, 32, v11
    v_xor_b32 v242, 64, v11
    v_xor_b32 v243, 96, v11
    v_xor_b32 v244, 128, v11
    v_xor_b32 v245, 160, v11
    v_xor_b32 v246, 192, v11
    v_xor_b32 v247, 224, v11
    s_barrier
    ds_read_b64_tr_b16 v[112:113], v240 offset:0
    ds_read_b64_tr_b16 v[114:115], v240 offset:4096
    ds_read_b64_tr_b16 v[116:117], v240 offset:8192
    ds_read_b64_tr_b16 v[118:119], v240 offset:12288
    ds_read_b64_tr_b16 v[120:121], v240 offset:16384
    ds_read_b64_tr_b16 v[122:123], v240 offset:20480
    ds_read_b64_tr_b16 v[124:125], v241 offset:0
    ds_read_b64_tr_b16 v[126:127], v241 offset:4096
    ds_read_b64_tr_b16 v[128:129], v241 offset:8192
    ds_read_b64_tr_b16 v[130:131], v241 offset:12288
    ds_read_b64_tr_b16 v[132:133], v241 offset:16384
    ds_read_b64_tr_b16 v[134:135], v241 offset:20480
    ds_read_b64_tr_b16 v[136:137], v242 offset:0
    ds_read_b64_tr_b16 v[138:139], v242 offset:4096
    ds_read_b64_tr_b16 v[140:141], v242 offset:8192
    ds_read_b64_tr_b16 v[142:143], v242 offset:12288
    ds_read_b64_tr_b16 v[176:177], v242 offset:16384
    ds_read_b64_tr_b16 v[178:179], v242 offset:20480
    ds_read_b64_tr_b16 v[180:181], v243 offset:0
    ds_read_b64_tr_b16 v[182:183], v243 offset:4096
    ds_read_b64_tr_b16 v[184:185], v243 offset:8192
    ds_read_b64_tr_b16 v[186:187], v243 offset:12288
    ds_read_b64_tr_b16 v[200:201], v243 offset:16384
    ds_read_b64_tr_b16 v[202:203], v243 offset:20480
    v_mfma_f32_16x16x32_bf16 v[192:195], v[12:15], v[156:159], 0
    v_max3_f32 v250, v28, v29, v30
    v_max3_f32 v249, v31, v52, v53
    v_mfma_f32_16x16x32_bf16 v[192:195], v[12:15], v[164:167], v[192:195]
    v_max3_f32 v250, v250, v54, v55
    v_max3_f32 v249, v249, v76, v77
    v_mfma_f32_16x16x32_bf16 v[192:195], v[12:15], v[172:175], v[192:195]
    v_max3_f32 v250, v250, v78, v79
    v_max3_f32 v249, v249, v100, v101
    s_waitcnt lgkmcnt(8)
    v_mfma_f32_16x16x32_bf16 v[16:19], v[112:115], v[156:159], 0
    v_max3_f32 v250, v250, v102, v103
    v_max3_f32 v249, v249, v32, v33
    v_mfma_f32_16x16x32_bf16 v[20:23], v[124:127], v[156:159], 0
    v_max3_f32 v250, v250, v34, v35
    v_max3_f32 v249, v249, v56, v57
    v_mfma_f32_16x16x32_bf16 v[16:19], v[116:119], v[164:167], v[16:19]
    v_max3_f32 v250, v250, v58, v59
    v_max_f32 v250, v250, v249
    v_mfma_f32_16x16x32_bf16 v[20:23], v[128:131], v[164:167], v[20:23]
    v_mov_b32 v251, v250
    s_nop 1
    v_permlane16_swap_b32 v250, v251
    v_mfma_f32_16x16x32_bf16 v[16:19], v[120:123], v[172:175], v[16:19]
    v_max_f32 v250, v250, v251
    v_mov_b32 v251, v250
    v_mfma_f32_16x16x32_bf16 v[20:23], v[132:135], v[172:175], v[20:23]
    s_nop 0
    v_permlane32_swap_b32 v250, v251
    v_max_f32 v250, v250, v251
    v_mfma_f32_16x16x32_bf16 v[24:27], v[136:139], v[156:159], 0
    v_mul_f32 v250, s63, v250
    v_fma_f32 v28, v28, s63, -v250
    s_waitcnt lgkmcnt(4)
    v_mfma_f32_16x16x32_bf16 v[40:43], v[180:183], v[156:159], 0
    v_fma_f32 v29, v29, s63, -v250
    v_fma_f32 v30, v30, s63, -v250
    v_mfma_f32_16x16x32_bf16 v[24:27], v[140:143], v[164:167], v[24:27]
    v_fma_f32 v31, v31, s63, -v250
    v_fma_f32 v52, v52, s63, -v250
    s_waitcnt lgkmcnt(2)
    v_mfma_f32_16x16x32_bf16 v[40:43], v[184:187], v[164:167], v[40:43]
    v_fma_f32 v53, v53, s63, -v250
    v_fma_f32 v54, v54, s63, -v250
    v_mfma_f32_16x16x32_bf16 v[24:27], v[176:179], v[172:175], v[24:27]
    v_fma_f32 v55, v55, s63, -v250
    s_waitcnt lgkmcnt(0)
    v_mfma_f32_16x16x32_bf16 v[40:43], v[200:203], v[172:175], v[40:43]
    v_exp_f32 v28, v28
    v_exp_f32 v29, v29
    v_exp_f32 v30, v30
    v_exp_f32 v31, v31
    v_exp_f32 v52, v52
    v_exp_f32 v53, v53
    v_exp_f32 v54, v54
    v_exp_f32 v55, v55
    v_cvt_pk_bf16_f32 v28, v28, v29
    v_cvt_pk_bf16_f32 v29, v30, v31
    v_cvt_pk_bf16_f32 v30, v52, v53
    v_cvt_pk_bf16_f32 v31, v54, v55
    v_fma_f32 v76, v76, s63, -v250
    v_fma_f32 v77, v77, s63, -v250
    v_fma_f32 v78, v78, s63, -v250
    v_fma_f32 v79, v79, s63, -v250
    v_fma_f32 v100, v100, s63, -v250
    v_fma_f32 v101, v101, s63, -v250
    v_fma_f32 v102, v102, s63, -v250
    v_fma_f32 v103, v103, s63, -v250
    v_exp_f32 v76, v76
    v_exp_f32 v77, v77
    v_exp_f32 v78, v78
    v_exp_f32 v79, v79
    v_exp_f32 v100, v100
    v_exp_f32 v101, v101
    v_exp_f32 v102, v102
    v_exp_f32 v103, v103
    v_cvt_pk_bf16_f32 v76, v76, v77
    v_cvt_pk_bf16_f32 v77, v78, v79
    v_cvt_pk_bf16_f32 v78, v100, v101
    v_cvt_pk_bf16_f32 v79, v102, v103
    v_fma_f32 v32, v32, s63, -v250
    v_fma_f32 v33, v33, s63, -v250
    v_fma_f32 v34, v34, s63, -v250
    v_fma_f32 v35, v35, s63, -v250
    v_fma_f32 v56, v56, s63, -v250
    v_fma_f32 v57, v57, s63, -v250
    v_fma_f32 v58, v58, s63, -v250
    v_fma_f32 v59, v59, s63, -v250
    v_exp_f32 v32, v32
    v_exp_f32 v33, v33
    v_exp_f32 v34, v34
    v_exp_f32 v35, v35
    v_exp_f32 v56, v56
    v_exp_f32 v57, v57
    v_exp_f32 v58, v58
    v_exp_f32 v59, v59
    v_cvt_pk_bf16_f32 v32, v32, v33
    v_cvt_pk_bf16_f32 v33, v34, v35
    v_cvt_pk_bf16_f32 v34, v56, v57
    v_cvt_pk_bf16_f32 v35, v58, v59
    v_mfma_f32_16x16x32_bf16 v[196:199], v[12:15], v[28:31], 0
    v_rcp_f32 v192, v192
    v_mfma_f32_16x16x32_bf16 v[196:199], v[12:15], v[76:79], v[196:199]
    v_mul_f32 v16, v16, v192
    v_mul_f32 v17, v17, v192
    v_mfma_f32_16x16x32_bf16 v[196:199], v[12:15], v[32:35], v[196:199]
    v_mul_f32 v18, v18, v192
    v_mul_f32 v19, v19, v192
    v_mfma_f32_16x16x32_bf16 v[44:47], v[112:115], v[28:31], 0
    v_mul_f32 v20, v20, v192
    v_mul_f32 v21, v21, v192
    v_mfma_f32_16x16x32_bf16 v[48:51], v[124:127], v[28:31], 0
    v_mul_f32 v22, v22, v192
    v_mul_f32 v23, v23, v192
    v_mfma_f32_16x16x32_bf16 v[44:47], v[116:119], v[76:79], v[44:47]
    v_cvt_pk_bf16_f32 v16, v16, v17
    v_cvt_pk_bf16_f32 v17, v18, v19
    v_mfma_f32_16x16x32_bf16 v[48:51], v[128:131], v[76:79], v[48:51]
    v_cvt_pk_bf16_f32 v18, v20, v21
    v_cvt_pk_bf16_f32 v19, v22, v23
    v_mfma_f32_16x16x32_bf16 v[44:47], v[120:123], v[32:35], v[44:47]
    buffer_store_dwordx4 v[16:19], v9, s[52:55], s16 offen offset:0 sc1
    v_mul_f32 v24, v24, v192
    v_mfma_f32_16x16x32_bf16 v[48:51], v[132:135], v[32:35], v[48:51]
    v_mul_f32 v25, v25, v192
    v_mul_f32 v26, v26, v192
    v_mfma_f32_16x16x32_bf16 v[64:67], v[136:139], v[28:31], 0
    v_mul_f32 v27, v27, v192
    v_mul_f32 v40, v40, v192
    v_mfma_f32_16x16x32_bf16 v[68:71], v[180:183], v[28:31], 0
    v_mul_f32 v41, v41, v192
    v_mul_f32 v42, v42, v192
    v_mfma_f32_16x16x32_bf16 v[64:67], v[140:143], v[76:79], v[64:67]
    v_mul_f32 v43, v43, v192
    v_cvt_pk_bf16_f32 v24, v24, v25
    v_mfma_f32_16x16x32_bf16 v[68:71], v[184:187], v[76:79], v[68:71]
    v_cvt_pk_bf16_f32 v25, v26, v27
    v_cvt_pk_bf16_f32 v26, v40, v41
    v_mfma_f32_16x16x32_bf16 v[64:67], v[176:179], v[32:35], v[64:67]
    v_cvt_pk_bf16_f32 v27, v42, v43
    buffer_store_dwordx4 v[24:27], v9, s[52:55], s17 offen offset:0 sc1
    v_mfma_f32_16x16x32_bf16 v[68:71], v[200:203], v[32:35], v[68:71]
    v_max3_f32 v250, v80, v81, v82
    v_max3_f32 v249, v83, v104, v105
    v_max3_f32 v250, v250, v106, v107
    v_max3_f32 v249, v249, v36, v37
    v_max3_f32 v250, v250, v38, v39
    v_max3_f32 v249, v249, v60, v61
    v_max3_f32 v250, v250, v62, v63
    v_max3_f32 v249, v249, v84, v85
    v_max3_f32 v250, v250, v86, v87
    v_max3_f32 v249, v249, v108, v109
    v_max3_f32 v250, v250, v110, v111
    v_max_f32 v250, v250, v249
    v_mov_b32 v251, v250
    s_nop 1
    v_permlane16_swap_b32 v250, v251
    v_max_f32 v250, v250, v251
    v_mov_b32 v251, v250
    s_nop 1
    v_permlane32_swap_b32 v250, v251
    v_max_f32 v250, v250, v251
    v_mul_f32 v250, s63, v250
    v_fma_f32 v80, v80, s63, -v250
    v_fma_f32 v81, v81, s63, -v250
    v_fma_f32 v82, v82, s63, -v250
    v_fma_f32 v83, v83, s63, -v250
    v_fma_f32 v104, v104, s63, -v250
    v_fma_f32 v105, v105, s63, -v250
    v_fma_f32 v106, v106, s63, -v250
    v_fma_f32 v107, v107, s63, -v250
    v_exp_f32 v80, v80
    v_exp_f32 v81, v81
    v_exp_f32 v82, v82
    v_exp_f32 v83, v83
    v_exp_f32 v104, v104
    v_exp_f32 v105, v105
    v_exp_f32 v106, v106
    v_exp_f32 v107, v107
    v_cvt_pk_bf16_f32 v80, v80, v81
    v_cvt_pk_bf16_f32 v81, v82, v83
    v_cvt_pk_bf16_f32 v82, v104, v105
    v_cvt_pk_bf16_f32 v83, v106, v107
    v_fma_f32 v36, v36, s63, -v250
    v_rcp_f32 v196, v196
    s_nop 0
    v_mul_f32 v44, v44, v196
    v_mul_f32 v45, v45, v196
    v_mul_f32 v46, v46, v196
    v_mul_f32 v47, v47, v196
    v_mul_f32 v48, v48, v196
    v_mul_f32 v49, v49, v196
    v_mul_f32 v50, v50, v196
    v_mul_f32 v51, v51, v196
    v_cvt_pk_bf16_f32 v44, v44, v45
    v_cvt_pk_bf16_f32 v45, v46, v47
    v_cvt_pk_bf16_f32 v46, v48, v49
    v_cvt_pk_bf16_f32 v47, v50, v51
    buffer_store_dwordx4 v[44:47], v9, s[52:55], s16 offen offset:1024 sc1
    v_mul_f32 v64, v64, v196
    v_mul_f32 v65, v65, v196
    v_mul_f32 v66, v66, v196
    v_mul_f32 v67, v67, v196
    v_mul_f32 v68, v68, v196
    v_mul_f32 v69, v69, v196
    v_mul_f32 v70, v70, v196
    v_mul_f32 v71, v71, v196
    v_cvt_pk_bf16_f32 v64, v64, v65
    v_cvt_pk_bf16_f32 v65, v66, v67
    v_cvt_pk_bf16_f32 v66, v68, v69
    v_cvt_pk_bf16_f32 v67, v70, v71
    buffer_store_dwordx4 v[64:67], v9, s[52:55], s17 offen offset:1024 sc1
    v_fma_f32 v37, v37, s63, -v250
    v_fma_f32 v38, v38, s63, -v250
    v_fma_f32 v39, v39, s63, -v250
    v_fma_f32 v60, v60, s63, -v250
    v_fma_f32 v61, v61, s63, -v250
    v_fma_f32 v62, v62, s63, -v250
    v_fma_f32 v63, v63, s63, -v250
    v_exp_f32 v36, v36
    v_exp_f32 v37, v37
    v_exp_f32 v38, v38
    v_exp_f32 v39, v39
    v_exp_f32 v60, v60
    v_exp_f32 v61, v61
    v_exp_f32 v62, v62
    v_exp_f32 v63, v63
    v_cvt_pk_bf16_f32 v36, v36, v37
    v_cvt_pk_bf16_f32 v37, v38, v39
    v_cvt_pk_bf16_f32 v38, v60, v61
    v_cvt_pk_bf16_f32 v39, v62, v63
    v_fma_f32 v84, v84, s63, -v250
    v_fma_f32 v85, v85, s63, -v250
    v_fma_f32 v86, v86, s63, -v250
    v_fma_f32 v87, v87, s63, -v250
    v_fma_f32 v108, v108, s63, -v250
    v_fma_f32 v109, v109, s63, -v250
    v_fma_f32 v110, v110, s63, -v250
    v_fma_f32 v111, v111, s63, -v250
    v_exp_f32 v84, v84
    v_exp_f32 v85, v85
    v_exp_f32 v86, v86
    v_exp_f32 v87, v87
    v_exp_f32 v108, v108
    v_exp_f32 v109, v109
    v_exp_f32 v110, v110
    v_exp_f32 v111, v111
    v_cvt_pk_bf16_f32 v84, v84, v85
    v_cvt_pk_bf16_f32 v85, v86, v87
    v_cvt_pk_bf16_f32 v86, v108, v109
    v_cvt_pk_bf16_f32 v87, v110, v111
    v_mfma_f32_16x16x32_bf16 v[160:163], v[12:15], v[80:83], 0
    ds_read_b64_tr_b16 v[204:205], v244 offset:0
    v_mfma_f32_16x16x32_bf16 v[160:163], v[12:15], v[36:39], v[160:163]
    ds_read_b64_tr_b16 v[206:207], v244 offset:4096
    v_mfma_f32_16x16x32_bf16 v[160:163], v[12:15], v[84:87], v[160:163]
    ds_read_b64_tr_b16 v[208:209], v244 offset:8192
    v_mfma_f32_16x16x32_bf16 v[72:75], v[112:115], v[80:83], 0
    ds_read_b64_tr_b16 v[210:211], v244 offset:12288
    v_mfma_f32_16x16x32_bf16 v[88:91], v[124:127], v[80:83], 0
    ds_read_b64_tr_b16 v[212:213], v244 offset:16384
    v_mfma_f32_16x16x32_bf16 v[72:75], v[116:119], v[36:39], v[72:75]
    ds_read_b64_tr_b16 v[214:215], v244 offset:20480
    v_mfma_f32_16x16x32_bf16 v[88:91], v[128:131], v[36:39], v[88:91]
    ds_read_b64_tr_b16 v[216:217], v245 offset:0
    v_mfma_f32_16x16x32_bf16 v[72:75], v[120:123], v[84:87], v[72:75]
    ds_read_b64_tr_b16 v[218:219], v245 offset:4096
    v_mfma_f32_16x16x32_bf16 v[88:91], v[132:135], v[84:87], v[88:91]
    ds_read_b64_tr_b16 v[220:221], v245 offset:8192
    v_mfma_f32_16x16x32_bf16 v[92:95], v[136:139], v[80:83], 0
    ds_read_b64_tr_b16 v[222:223], v245 offset:12288
    v_mfma_f32_16x16x32_bf16 v[96:99], v[180:183], v[80:83], 0
    ds_read_b64_tr_b16 v[224:225], v245 offset:16384
    v_mfma_f32_16x16x32_bf16 v[92:95], v[140:143], v[36:39], v[92:95]
    ds_read_b64_tr_b16 v[226:227], v245 offset:20480
    v_mfma_f32_16x16x32_bf16 v[96:99], v[184:187], v[36:39], v[96:99]
    ds_read_b64_tr_b16 v[228:229], v246 offset:0
    v_mfma_f32_16x16x32_bf16 v[92:95], v[176:179], v[84:87], v[92:95]
    ds_read_b64_tr_b16 v[230:231], v246 offset:4096
    v_mfma_f32_16x16x32_bf16 v[96:99], v[200:203], v[84:87], v[96:99]
    ds_read_b64_tr_b16 v[232:233], v246 offset:8192
    ds_read_b64_tr_b16 v[234:235], v246 offset:12288
    ds_read_b64_tr_b16 v[236:237], v246 offset:16384
    ds_read_b64_tr_b16 v[238:239], v246 offset:20480
    ds_read_b64_tr_b16 v[144:145], v247 offset:0
    ds_read_b64_tr_b16 v[146:147], v247 offset:4096
    ds_read_b64_tr_b16 v[148:149], v247 offset:8192
    ds_read_b64_tr_b16 v[150:151], v247 offset:12288
    ds_read_b64_tr_b16 v[152:153], v247 offset:16384
    ds_read_b64_tr_b16 v[154:155], v247 offset:20480
    v_rcp_f32 v160, v160
    s_nop 0
    v_mul_f32 v72, v72, v160
    v_mul_f32 v73, v73, v160
    v_mul_f32 v74, v74, v160
    v_mul_f32 v75, v75, v160
    v_mul_f32 v88, v88, v160
    v_mul_f32 v89, v89, v160
    v_mul_f32 v90, v90, v160
    v_mul_f32 v91, v91, v160
    v_cvt_pk_bf16_f32 v72, v72, v73
    v_cvt_pk_bf16_f32 v73, v74, v75
    v_cvt_pk_bf16_f32 v74, v88, v89
    v_cvt_pk_bf16_f32 v75, v90, v91
    buffer_store_dwordx4 v[72:75], v9, s[52:55], s16 offen offset:2048 sc1
    v_mul_f32 v92, v92, v160
    v_mul_f32 v93, v93, v160
    v_mul_f32 v94, v94, v160
    v_mul_f32 v95, v95, v160
    v_mul_f32 v96, v96, v160
    v_mul_f32 v97, v97, v160
    v_mul_f32 v98, v98, v160
    v_mul_f32 v99, v99, v160
    v_cvt_pk_bf16_f32 v92, v92, v93
    v_cvt_pk_bf16_f32 v93, v94, v95
    v_cvt_pk_bf16_f32 v94, v96, v97
    v_cvt_pk_bf16_f32 v95, v98, v99
    buffer_store_dwordx4 v[92:95], v9, s[52:55], s17 offen offset:2048 sc1
    s_waitcnt lgkmcnt(8)
    v_mfma_f32_16x16x32_bf16 v[168:171], v[204:207], v[156:159], 0
    v_mfma_f32_16x16x32_bf16 v[188:191], v[216:219], v[156:159], 0
    v_mfma_f32_16x16x32_bf16 v[168:171], v[208:211], v[164:167], v[168:171]
    v_mfma_f32_16x16x32_bf16 v[188:191], v[220:223], v[164:167], v[188:191]
    v_mfma_f32_16x16x32_bf16 v[168:171], v[212:215], v[172:175], v[168:171]
    v_mfma_f32_16x16x32_bf16 v[188:191], v[224:227], v[172:175], v[188:191]
    v_mfma_f32_16x16x32_bf16 v[52:55], v[228:231], v[156:159], 0
    s_waitcnt lgkmcnt(4)
    v_mfma_f32_16x16x32_bf16 v[100:103], v[144:147], v[156:159], 0
    v_mfma_f32_16x16x32_bf16 v[52:55], v[232:235], v[164:167], v[52:55]
    s_waitcnt lgkmcnt(2)
    v_mfma_f32_16x16x32_bf16 v[100:103], v[148:151], v[164:167], v[100:103]
    v_mfma_f32_16x16x32_bf16 v[52:55], v[236:239], v[172:175], v[52:55]
    s_waitcnt lgkmcnt(0)
    v_mfma_f32_16x16x32_bf16 v[100:103], v[152:155], v[172:175], v[100:103]
    v_mfma_f32_16x16x32_bf16 v[56:59], v[204:207], v[28:31], 0
    v_mul_f32 v168, v168, v192
    v_mul_f32 v169, v169, v192
    v_mfma_f32_16x16x32_bf16 v[104:107], v[216:219], v[28:31], 0
    v_mul_f32 v170, v170, v192
    v_mul_f32 v171, v171, v192
    v_mfma_f32_16x16x32_bf16 v[56:59], v[208:211], v[76:79], v[56:59]
    v_mul_f32 v188, v188, v192
    v_mul_f32 v189, v189, v192
    v_mfma_f32_16x16x32_bf16 v[104:107], v[220:223], v[76:79], v[104:107]
    v_mul_f32 v190, v190, v192
    v_mul_f32 v191, v191, v192
    v_mfma_f32_16x16x32_bf16 v[56:59], v[212:215], v[32:35], v[56:59]
    v_cvt_pk_bf16_f32 v168, v168, v169
    v_cvt_pk_bf16_f32 v169, v170, v171
    v_mfma_f32_16x16x32_bf16 v[104:107], v[224:227], v[32:35], v[104:107]
    v_cvt_pk_bf16_f32 v170, v188, v189
    v_cvt_pk_bf16_f32 v171, v190, v191
    v_mfma_f32_16x16x32_bf16 v[60:63], v[228:231], v[28:31], 0
    buffer_store_dwordx4 v[168:171], v9, s[52:55], s18 offen offset:0 sc1
    v_mul_f32 v52, v52, v192
    v_mfma_f32_16x16x32_bf16 v[108:111], v[144:147], v[28:31], 0
    v_mul_f32 v53, v53, v192
    v_mul_f32 v54, v54, v192
    v_mfma_f32_16x16x32_bf16 v[60:63], v[232:235], v[76:79], v[60:63]
    v_mul_f32 v55, v55, v192
    v_mul_f32 v100, v100, v192
    v_mfma_f32_16x16x32_bf16 v[108:111], v[148:151], v[76:79], v[108:111]
    v_mul_f32 v101, v101, v192
    v_mul_f32 v102, v102, v192
    v_mfma_f32_16x16x32_bf16 v[60:63], v[236:239], v[32:35], v[60:63]
    v_mul_f32 v103, v103, v192
    v_cvt_pk_bf16_f32 v52, v52, v53
    v_mfma_f32_16x16x32_bf16 v[108:111], v[152:155], v[32:35], v[108:111]
    v_cvt_pk_bf16_f32 v53, v54, v55
    v_cvt_pk_bf16_f32 v54, v100, v101
    v_cvt_pk_bf16_f32 v55, v102, v103
    buffer_store_dwordx4 v[52:55], v9, s[52:55], s19 offen offset:0 sc1
    v_mfma_f32_16x16x32_bf16 v[112:115], v[204:207], v[80:83], 0
    v_mul_f32 v56, v56, v196
    v_mul_f32 v57, v57, v196
    v_mfma_f32_16x16x32_bf16 v[116:119], v[216:219], v[80:83], 0
    v_mul_f32 v58, v58, v196
    v_mul_f32 v59, v59, v196
    v_mfma_f32_16x16x32_bf16 v[112:115], v[208:211], v[36:39], v[112:115]
    v_mul_f32 v104, v104, v196
    v_mul_f32 v105, v105, v196
    v_mfma_f32_16x16x32_bf16 v[116:119], v[220:223], v[36:39], v[116:119]
    v_mul_f32 v106, v106, v196
    v_mul_f32 v107, v107, v196
    v_mfma_f32_16x16x32_bf16 v[112:115], v[212:215], v[84:87], v[112:115]
    v_cvt_pk_bf16_f32 v56, v56, v57
    v_cvt_pk_bf16_f32 v57, v58, v59
    v_mfma_f32_16x16x32_bf16 v[116:119], v[224:227], v[84:87], v[116:119]
    v_cvt_pk_bf16_f32 v58, v104, v105
    v_cvt_pk_bf16_f32 v59, v106, v107
    v_mfma_f32_16x16x32_bf16 v[120:123], v[228:231], v[80:83], 0
    buffer_store_dwordx4 v[56:59], v9, s[52:55], s18 offen offset:1024 sc1
    v_mul_f32 v60, v60, v196
    v_mfma_f32_16x16x32_bf16 v[124:127], v[144:147], v[80:83], 0
    v_mul_f32 v61, v61, v196
    v_mul_f32 v62, v62, v196
    v_mfma_f32_16x16x32_bf16 v[120:123], v[232:235], v[36:39], v[120:123]
    v_mul_f32 v63, v63, v196
    v_mul_f32 v108, v108, v196
    v_mfma_f32_16x16x32_bf16 v[124:127], v[148:151], v[36:39], v[124:127]
    v_mul_f32 v109, v109, v196
    v_mul_f32 v110, v110, v196
    v_mfma_f32_16x16x32_bf16 v[120:123], v[236:239], v[84:87], v[120:123]
    v_mul_f32 v111, v111, v196
    v_cvt_pk_bf16_f32 v60, v60, v61
    v_mfma_f32_16x16x32_bf16 v[124:127], v[152:155], v[84:87], v[124:127]
    v_cvt_pk_bf16_f32 v61, v62, v63
    v_cvt_pk_bf16_f32 v62, v108, v109
    v_cvt_pk_bf16_f32 v63, v110, v111
    buffer_store_dwordx4 v[60:63], v9, s[52:55], s19 offen offset:1024 sc1
    s_waitcnt vmcnt(4)
    s_mov_b64 exec, 1
    buffer_store_dwordx2 v[254:255], v253, s[52:55], s69 offen sc1
    s_mov_b64 exec, -1
    v_mul_f32 v112, v112, v160
    v_mul_f32 v113, v113, v160
    v_mul_f32 v114, v114, v160
    v_mul_f32 v115, v115, v160
    v_mul_f32 v116, v116, v160
    v_mul_f32 v117, v117, v160
    v_mul_f32 v118, v118, v160
    v_mul_f32 v119, v119, v160
    v_cvt_pk_bf16_f32 v112, v112, v113
    v_cvt_pk_bf16_f32 v113, v114, v115
    v_cvt_pk_bf16_f32 v114, v116, v117
    v_cvt_pk_bf16_f32 v115, v118, v119
    buffer_store_dwordx4 v[112:115], v9, s[52:55], s18 offen offset:2048 sc1
    v_mul_f32 v120, v120, v160
    v_mul_f32 v121, v121, v160
    v_mul_f32 v122, v122, v160
    v_mul_f32 v123, v123, v160
    v_mul_f32 v124, v124, v160
    v_mul_f32 v125, v125, v160
    v_mul_f32 v126, v126, v160
    v_mul_f32 v127, v127, v160
    v_cvt_pk_bf16_f32 v120, v120, v121
    v_cvt_pk_bf16_f32 v121, v122, v123
    v_cvt_pk_bf16_f32 v122, v124, v125
    v_cvt_pk_bf16_f32 v123, v126, v127
    buffer_store_dwordx4 v[120:123], v9, s[52:55], s19 offen offset:2048 sc1
    s_barrier
    s_lshr_b32 s13, s3, 1
    s_lshl_b32 s13, s13, 7
    v_add_u32 v8, 65536, v6
    v_xor_b32 v8, s13, v8
    v_xor_b32 v240, 0, v8
    v_xor_b32 v241, 32, v8
    v_xor_b32 v242, 64, v8
    v_xor_b32 v243, 96, v8
    v_add_u32 v232, 0x10000, v240
    v_add_u32 v233, 0x10000, v241
    v_add_u32 v234, 0x10000, v242
    v_add_u32 v235, 0x10000, v243
    s_lshl_b32 s13, s12, 10
    v_add_u32 v8, s13, v9
    v_xor_b32 v244, 0, v8
    v_xor_b32 v245, 1024, v8
    v_xor_b32 v246, 2048, v8
    v_xor_b32 v247, 3072, v8
    v_lshlrev_b32 v248, 7, v2
    v_mul_u32_u24 v7, 2560, v4
    v_lshl_add_u32 v7, v3, 3, v7
    s_cmp_lt_u32 s5, 30
    s_cbranch_scc1 L_act
    s_waitcnt vmcnt(0)
    s_mov_b64 exec, 1
    buffer_store_dwordx2 v[254:255], v253, s[52:55], s69 offen offset:1024 sc1
    s_mov_b64 exec, -1
    s_branch L_cdone
L_act:
    s_barrier
    s_waitcnt vmcnt(0)
    s_mov_b64 exec, 1
    buffer_store_dwordx2 v[254:255], v253, s[52:55], s69 offen offset:1024 sc1
    s_mov_b64 exec, -1
    v_mov_b32 v16, 0
    v_mov_b32 v17, 0
    v_mov_b32 v18, 0
    v_mov_b32 v19, 0
    v_mov_b32 v20, 0
    v_mov_b32 v21, 0
    v_mov_b32 v22, 0
    v_mov_b32 v23, 0
    v_mov_b32 v24, 0
    v_mov_b32 v25, 0
    v_mov_b32 v26, 0
    v_mov_b32 v27, 0
    v_mov_b32 v28, 0
    v_mov_b32 v29, 0
    v_mov_b32 v30, 0
    v_mov_b32 v31, 0
    v_mov_b32 v32, 0
    v_mov_b32 v33, 0
    v_mov_b32 v34, 0
    v_mov_b32 v35, 0
    v_mov_b32 v36, 0
    v_mov_b32 v37, 0
    v_mov_b32 v38, 0
    v_mov_b32 v39, 0
    v_mov_b32 v40, 0
    v_mov_b32 v41, 0
    v_mov_b32 v42, 0
    v_mov_b32 v43, 0
    v_mov_b32 v44, 0
    v_mov_b32 v45, 0
    v_mov_b32 v46, 0
    v_mov_b32 v47, 0
    v_mov_b32 v48, 0
    v_mov_b32 v49, 0
    v_mov_b32 v50, 0
    v_mov_b32 v51, 0
    v_mov_b32 v52, 0
    v_mov_b32 v53, 0
    v_mov_b32 v54, 0
    v_mov_b32 v55, 0
    v_mov_b32 v56, 0
    v_mov_b32 v57, 0
    v_mov_b32 v58, 0
    v_mov_b32 v59, 0
    v_mov_b32 v60, 0
    v_mov_b32 v61, 0
    v_mov_b32 v62, 0
    v_mov_b32 v63, 0
    v_mov_b32 v64, 0
    v_mov_b32 v65, 0
    v_mov_b32 v66, 0
    v_mov_b32 v67, 0
    v_mov_b32 v68, 0
    v_mov_b32 v69, 0
    v_mov_b32 v70, 0
    v_mov_b32 v71, 0
    v_mov_b32 v72, 0
    v_mov_b32 v73, 0
    v_mov_b32 v74, 0
    v_mov_b32 v75, 0
    v_mov_b32 v76, 0
    v_mov_b32 v77, 0
    v_mov_b32 v78, 0
    v_mov_b32 v79, 0
    s_mov_b32 s14, 0
    s_mov_b32 s15, 0
    s_barrier
    ds_read_b128 v[100:103], v245 offset:0
    ds_read_b64_tr_b16 v[80:81], v240 offset:16384
    ds_read_b64_tr_b16 v[82:83], v240 offset:20480
    ds_read_b64_tr_b16 v[84:85], v241 offset:16384
    ds_read_b64_tr_b16 v[86:87], v241 offset:20480
    ds_read_b128 v[104:107], v246 offset:0
    ds_read_b64_tr_b16 v[88:89], v242 offset:16384
    ds_read_b64_tr_b16 v[90:91], v242 offset:20480
    ds_read_b128 v[108:111], v247 offset:0
    ds_read_b64_tr_b16 v[92:93], v243 offset:16384
    ds_read_b64_tr_b16 v[94:95], v243 offset:20480
    ds_read_b128 v[96:99], v244 offset:0
    s_mov_b32 s13, 0
L_s0:
    s_waitcnt lgkmcnt(6)
    v_mfma_f32_16x16x32_bf16 v[32:35], v[80:83], v[100:103], v[32:35]
    ds_read_b128 v[132:135], v245 offset:8192
    v_mfma_f32_16x16x32_bf16 v[36:39], v[84:87], v[100:103], v[36:39]
    ds_read_b64_tr_b16 v[112:113], v240 offset:24576
    v_mfma_f32_16x16x32_bf16 v[52:55], v[84:87], v[104:107], v[52:55]
    ds_read_b64_tr_b16 v[114:115], v240 offset:28672
    v_mfma_f32_16x16x32_bf16 v[48:51], v[80:83], v[104:107], v[48:51]
    ds_read_b64_tr_b16 v[116:117], v241 offset:24576
    s_waitcnt lgkmcnt(7)
    v_mfma_f32_16x16x32_bf16 v[40:43], v[88:91], v[100:103], v[40:43]
    ds_read_b64_tr_b16 v[118:119], v241 offset:28672
    v_mfma_f32_16x16x32_bf16 v[56:59], v[88:91], v[104:107], v[56:59]
    ds_read_b128 v[136:139], v246 offset:8192
    v_mfma_f32_16x16x32_bf16 v[72:75], v[88:91], v[108:111], v[72:75]
    ds_read_b64_tr_b16 v[120:121], v242 offset:24576
    v_mfma_f32_16x16x32_bf16 v[68:71], v[84:87], v[108:111], v[68:71]
    ds_read_b64_tr_b16 v[122:123], v242 offset:28672
    v_mfma_f32_16x16x32_bf16 v[64:67], v[80:83], v[108:111], v[64:67]
    ds_read_b128 v[140:143], v247 offset:8192
    s_waitcnt lgkmcnt(9)
    v_mfma_f32_16x16x32_bf16 v[44:47], v[92:95], v[100:103], v[44:47]
    ds_read_b64_tr_b16 v[124:125], v243 offset:24576
    v_mfma_f32_16x16x32_bf16 v[60:63], v[92:95], v[104:107], v[60:63]
    ds_read_b64_tr_b16 v[126:127], v243 offset:28672
    v_mfma_f32_16x16x32_bf16 v[76:79], v[92:95], v[108:111], v[76:79]
    ds_read_b128 v[128:131], v244 offset:8192
    v_mfma_f32_16x16x32_bf16 v[28:31], v[92:95], v[96:99], v[28:31]
    v_mfma_f32_16x16x32_bf16 v[24:27], v[88:91], v[96:99], v[24:27]
    v_mfma_f32_16x16x32_bf16 v[20:23], v[84:87], v[96:99], v[20:23]
    v_mfma_f32_16x16x32_bf16 v[16:19], v[80:83], v[96:99], v[16:19]
    s_waitcnt lgkmcnt(6)
    v_mfma_f32_16x16x32_bf16 v[32:35], v[112:115], v[132:135], v[32:35]
    v_mfma_f32_16x16x32_bf16 v[36:39], v[116:119], v[132:135], v[36:39]
    v_mfma_f32_16x16x32_bf16 v[52:55], v[116:119], v[136:139], v[52:55]
    v_mfma_f32_16x16x32_bf16 v[48:51], v[112:115], v[136:139], v[48:51]
    s_waitcnt lgkmcnt(0)
    s_barrier
    v_mfma_f32_16x16x32_bf16 v[40:43], v[120:123], v[132:135], v[40:43]
    ds_read_b128 v[100:103], v245 offset:16384
    v_mfma_f32_16x16x32_bf16 v[56:59], v[120:123], v[136:139], v[56:59]
    ds_read_b64_tr_b16 v[80:81], v240 offset:32768
    v_mfma_f32_16x16x32_bf16 v[72:75], v[120:123], v[140:143], v[72:75]
    ds_read_b64_tr_b16 v[82:83], v240 offset:36864
    v_mfma_f32_16x16x32_bf16 v[68:71], v[116:119], v[140:143], v[68:71]
    ds_read_b64_tr_b16 v[84:85], v241 offset:32768
    v_mfma_f32_16x16x32_bf16 v[64:67], v[112:115], v[140:143], v[64:67]
    ds_read_b64_tr_b16 v[86:87], v241 offset:36864
    v_mfma_f32_16x16x32_bf16 v[44:47], v[124:127], v[132:135], v[44:47]
    ds_read_b128 v[104:107], v246 offset:16384
    v_mfma_f32_16x16x32_bf16 v[60:63], v[124:127], v[136:139], v[60:63]
    ds_read_b64_tr_b16 v[88:89], v242 offset:32768
    v_mfma_f32_16x16x32_bf16 v[76:79], v[124:127], v[140:143], v[76:79]
    ds_read_b64_tr_b16 v[90:91], v242 offset:36864
    v_mfma_f32_16x16x32_bf16 v[28:31], v[124:127], v[128:131], v[28:31]
    ds_read_b128 v[108:111], v247 offset:16384
    v_mfma_f32_16x16x32_bf16 v[24:27], v[120:123], v[128:131], v[24:27]
    ds_read_b64_tr_b16 v[92:93], v243 offset:32768
    v_mfma_f32_16x16x32_bf16 v[20:23], v[116:119], v[128:131], v[20:23]
    ds_read_b64_tr_b16 v[94:95], v243 offset:36864
    v_mfma_f32_16x16x32_bf16 v[16:19], v[112:115], v[128:131], v[16:19]
    ds_read_b128 v[96:99], v244 offset:16384
L_s1:
    s_waitcnt lgkmcnt(6)
    v_mfma_f32_16x16x32_bf16 v[32:35], v[80:83], v[100:103], v[32:35]
    ds_read_b128 v[132:135], v245 offset:24576
    v_mfma_f32_16x16x32_bf16 v[36:39], v[84:87], v[100:103], v[36:39]
    ds_read_b64_tr_b16 v[112:113], v240 offset:40960
    v_mfma_f32_16x16x32_bf16 v[52:55], v[84:87], v[104:107], v[52:55]
    ds_read_b64_tr_b16 v[114:115], v240 offset:45056
    v_mfma_f32_16x16x32_bf16 v[48:51], v[80:83], v[104:107], v[48:51]
    ds_read_b64_tr_b16 v[116:117], v241 offset:40960
    s_waitcnt lgkmcnt(7)
    v_mfma_f32_16x16x32_bf16 v[40:43], v[88:91], v[100:103], v[40:43]
    ds_read_b64_tr_b16 v[118:119], v241 offset:45056
    v_mfma_f32_16x16x32_bf16 v[56:59], v[88:91], v[104:107], v[56:59]
    ds_read_b128 v[136:139], v246 offset:24576
    v_mfma_f32_16x16x32_bf16 v[72:75], v[88:91], v[108:111], v[72:75]
    ds_read_b64_tr_b16 v[120:121], v242 offset:40960
    v_mfma_f32_16x16x32_bf16 v[68:71], v[84:87], v[108:111], v[68:71]
    ds_read_b64_tr_b16 v[122:123], v242 offset:45056
    v_mfma_f32_16x16x32_bf16 v[64:67], v[80:83], v[108:111], v[64:67]
    ds_read_b128 v[140:143], v247 offset:24576
    s_waitcnt lgkmcnt(9)
    v_mfma_f32_16x16x32_bf16 v[44:47], v[92:95], v[100:103], v[44:47]
    ds_read_b64_tr_b16 v[124:125], v243 offset:40960
    v_mfma_f32_16x16x32_bf16 v[60:63], v[92:95], v[104:107], v[60:63]
    ds_read_b64_tr_b16 v[126:127], v243 offset:45056
    v_mfma_f32_16x16x32_bf16 v[76:79], v[92:95], v[108:111], v[76:79]
    ds_read_b128 v[128:131], v244 offset:24576
    v_mfma_f32_16x16x32_bf16 v[28:31], v[92:95], v[96:99], v[28:31]
    v_mfma_f32_16x16x32_bf16 v[24:27], v[88:91], v[96:99], v[24:27]
    v_mfma_f32_16x16x32_bf16 v[20:23], v[84:87], v[96:99], v[20:23]
    v_mfma_f32_16x16x32_bf16 v[16:19], v[80:83], v[96:99], v[16:19]
    s_waitcnt lgkmcnt(6)
    v_mfma_f32_16x16x32_bf16 v[32:35], v[112:115], v[132:135], v[32:35]
    v_mfma_f32_16x16x32_bf16 v[36:39], v[116:119], v[132:135], v[36:39]
    v_mfma_f32_16x16x32_bf16 v[52:55], v[116:119], v[136:139], v[52:55]
    v_mfma_f32_16x16x32_bf16 v[48:51], v[112:115], v[136:139], v[48:51]
    s_waitcnt lgkmcnt(0)
    s_barrier
    v_mfma_f32_16x16x32_bf16 v[40:43], v[120:123], v[132:135], v[40:43]
    ds_read_b128 v[100:103], v245 offset:32768
    v_mfma_f32_16x16x32_bf16 v[56:59], v[120:123], v[136:139], v[56:59]
    ds_read_b64_tr_b16 v[80:81], v240 offset:49152
    v_mfma_f32_16x16x32_bf16 v[72:75], v[120:123], v[140:143], v[72:75]
    ds_read_b64_tr_b16 v[82:83], v240 offset:53248
    v_mfma_f32_16x16x32_bf16 v[68:71], v[116:119], v[140:143], v[68:71]
    ds_read_b64_tr_b16 v[84:85], v241 offset:49152
    v_mfma_f32_16x16x32_bf16 v[64:67], v[112:115], v[140:143], v[64:67]
    ds_read_b64_tr_b16 v[86:87], v241 offset:53248
    v_mfma_f32_16x16x32_bf16 v[44:47], v[124:127], v[132:135], v[44:47]
    ds_read_b128 v[104:107], v246 offset:32768
    v_mfma_f32_16x16x32_bf16 v[60:63], v[124:127], v[136:139], v[60:63]
    ds_read_b64_tr_b16 v[88:89], v242 offset:49152
    v_mfma_f32_16x16x32_bf16 v[76:79], v[124:127], v[140:143], v[76:79]
    ds_read_b64_tr_b16 v[90:91], v242 offset:53248
    v_mfma_f32_16x16x32_bf16 v[28:31], v[124:127], v[128:131], v[28:31]
    ds_read_b128 v[108:111], v247 offset:32768
    v_mfma_f32_16x16x32_bf16 v[24:27], v[120:123], v[128:131], v[24:27]
    ds_read_b64_tr_b16 v[92:93], v243 offset:49152
    v_mfma_f32_16x16x32_bf16 v[20:23], v[116:119], v[128:131], v[20:23]
    ds_read_b64_tr_b16 v[94:95], v243 offset:53248
    v_mfma_f32_16x16x32_bf16 v[16:19], v[112:115], v[128:131], v[16:19]
    ds_read_b128 v[96:99], v244 offset:32768
L_s2:
    s_waitcnt lgkmcnt(6)
    v_mfma_f32_16x16x32_bf16 v[32:35], v[80:83], v[100:103], v[32:35]
    ds_read_b128 v[132:135], v245 offset:40960
    v_mfma_f32_16x16x32_bf16 v[36:39], v[84:87], v[100:103], v[36:39]
    ds_read_b64_tr_b16 v[112:113], v240 offset:57344
    v_mfma_f32_16x16x32_bf16 v[52:55], v[84:87], v[104:107], v[52:55]
    ds_read_b64_tr_b16 v[114:115], v240 offset:61440
    v_mfma_f32_16x16x32_bf16 v[48:51], v[80:83], v[104:107], v[48:51]
    ds_read_b64_tr_b16 v[116:117], v241 offset:57344
    s_waitcnt lgkmcnt(7)
    v_mfma_f32_16x16x32_bf16 v[40:43], v[88:91], v[100:103], v[40:43]
    ds_read_b64_tr_b16 v[118:119], v241 offset:61440
    v_mfma_f32_16x16x32_bf16 v[56:59], v[88:91], v[104:107], v[56:59]
    ds_read_b128 v[136:139], v246 offset:40960
    v_mfma_f32_16x16x32_bf16 v[72:75], v[88:91], v[108:111], v[72:75]
    ds_read_b64_tr_b16 v[120:121], v242 offset:57344
    v_mfma_f32_16x16x32_bf16 v[68:71], v[84:87], v[108:111], v[68:71]
    ds_read_b64_tr_b16 v[122:123], v242 offset:61440
    v_mfma_f32_16x16x32_bf16 v[64:67], v[80:83], v[108:111], v[64:67]
    ds_read_b128 v[140:143], v247 offset:40960
    s_waitcnt lgkmcnt(9)
    v_mfma_f32_16x16x32_bf16 v[44:47], v[92:95], v[100:103], v[44:47]
    ds_read_b64_tr_b16 v[124:125], v243 offset:57344
    v_mfma_f32_16x16x32_bf16 v[60:63], v[92:95], v[104:107], v[60:63]
    ds_read_b64_tr_b16 v[126:127], v243 offset:61440
    v_mfma_f32_16x16x32_bf16 v[76:79], v[92:95], v[108:111], v[76:79]
    ds_read_b128 v[128:131], v244 offset:40960
    v_mfma_f32_16x16x32_bf16 v[28:31], v[92:95], v[96:99], v[28:31]
    v_mfma_f32_16x16x32_bf16 v[24:27], v[88:91], v[96:99], v[24:27]
    v_mfma_f32_16x16x32_bf16 v[20:23], v[84:87], v[96:99], v[20:23]
    v_mfma_f32_16x16x32_bf16 v[16:19], v[80:83], v[96:99], v[16:19]
    s_waitcnt lgkmcnt(6)
    v_mfma_f32_16x16x32_bf16 v[32:35], v[112:115], v[132:135], v[32:35]
    v_mfma_f32_16x16x32_bf16 v[36:39], v[116:119], v[132:135], v[36:39]
    v_mfma_f32_16x16x32_bf16 v[52:55], v[116:119], v[136:139], v[52:55]
    v_mfma_f32_16x16x32_bf16 v[48:51], v[112:115], v[136:139], v[48:51]
    s_waitcnt lgkmcnt(0)
    s_barrier
    v_mfma_f32_16x16x32_bf16 v[40:43], v[120:123], v[132:135], v[40:43]
    ds_read_b128 v[100:103], v245 offset:49152
    v_mfma_f32_16x16x32_bf16 v[56:59], v[120:123], v[136:139], v[56:59]
    ds_read_b64_tr_b16 v[80:81], v232 offset:0
    v_mfma_f32_16x16x32_bf16 v[72:75], v[120:123], v[140:143], v[72:75]
    ds_read_b64_tr_b16 v[82:83], v232 offset:4096
    v_mfma_f32_16x16x32_bf16 v[68:71], v[116:119], v[140:143], v[68:71]
    ds_read_b64_tr_b16 v[84:85], v233 offset:0
    v_mfma_f32_16x16x32_bf16 v[64:67], v[112:115], v[140:143], v[64:67]
    ds_read_b64_tr_b16 v[86:87], v233 offset:4096
    v_mfma_f32_16x16x32_bf16 v[44:47], v[124:127], v[132:135], v[44:47]
    ds_read_b128 v[104:107], v246 offset:49152
    v_mfma_f32_16x16x32_bf16 v[60:63], v[124:127], v[136:139], v[60:63]
    ds_read_b64_tr_b16 v[88:89], v234 offset:0
    v_mfma_f32_16x16x32_bf16 v[76:79], v[124:127], v[140:143], v[76:79]
    ds_read_b64_tr_b16 v[90:91], v234 offset:4096
    v_mfma_f32_16x16x32_bf16 v[28:31], v[124:127], v[128:131], v[28:31]
    ds_read_b128 v[108:111], v247 offset:49152
    v_mfma_f32_16x16x32_bf16 v[24:27], v[120:123], v[128:131], v[24:27]
    ds_read_b64_tr_b16 v[92:93], v235 offset:0
    v_mfma_f32_16x16x32_bf16 v[20:23], v[116:119], v[128:131], v[20:23]
    ds_read_b64_tr_b16 v[94:95], v235 offset:4096
    v_mfma_f32_16x16x32_bf16 v[16:19], v[112:115], v[128:131], v[16:19]
    ds_read_b128 v[96:99], v244 offset:49152
L_s3:
    s_waitcnt lgkmcnt(6)
    v_mfma_f32_16x16x32_bf16 v[32:35], v[80:83], v[100:103], v[32:35]
    ds_read_b128 v[132:135], v245 offset:57344
    v_mfma_f32_16x16x32_bf16 v[36:39], v[84:87], v[100:103], v[36:39]
    ds_read_b64_tr_b16 v[112:113], v232 offset:8192
    v_mfma_f32_16x16x32_bf16 v[52:55], v[84:87], v[104:107], v[52:55]
    ds_read_b64_tr_b16 v[114:115], v232 offset:12288
    v_mfma_f32_16x16x32_bf16 v[48:51], v[80:83], v[104:107], v[48:51]
    ds_read_b64_tr_b16 v[116:117], v233 offset:8192
    s_waitcnt lgkmcnt(7)
    v_mfma_f32_16x16x32_bf16 v[40:43], v[88:91], v[100:103], v[40:43]
    ds_read_b64_tr_b16 v[118:119], v233 offset:12288
    v_mfma_f32_16x16x32_bf16 v[56:59], v[88:91], v[104:107], v[56:59]
    ds_read_b128 v[136:139], v246 offset:57344
    v_mfma_f32_16x16x32_bf16 v[72:75], v[88:91], v[108:111], v[72:75]
    ds_read_b64_tr_b16 v[120:121], v234 offset:8192
    v_mfma_f32_16x16x32_bf16 v[68:71], v[84:87], v[108:111], v[68:71]
    ds_read_b64_tr_b16 v[122:123], v234 offset:12288
    v_mfma_f32_16x16x32_bf16 v[64:67], v[80:83], v[108:111], v[64:67]
    ds_read_b128 v[140:143], v247 offset:57344
    s_waitcnt lgkmcnt(9)
    v_mfma_f32_16x16x32_bf16 v[44:47], v[92:95], v[100:103], v[44:47]
    ds_read_b64_tr_b16 v[124:125], v235 offset:8192
    v_mfma_f32_16x16x32_bf16 v[60:63], v[92:95], v[104:107], v[60:63]
    ds_read_b64_tr_b16 v[126:127], v235 offset:12288
    v_mfma_f32_16x16x32_bf16 v[76:79], v[92:95], v[108:111], v[76:79]
    ds_read_b128 v[128:131], v244 offset:57344
    v_mfma_f32_16x16x32_bf16 v[28:31], v[92:95], v[96:99], v[28:31]
    v_mfma_f32_16x16x32_bf16 v[24:27], v[88:91], v[96:99], v[24:27]
    v_mfma_f32_16x16x32_bf16 v[20:23], v[84:87], v[96:99], v[20:23]
    v_mfma_f32_16x16x32_bf16 v[16:19], v[80:83], v[96:99], v[16:19]
    s_waitcnt lgkmcnt(6)
    v_mfma_f32_16x16x32_bf16 v[32:35], v[112:115], v[132:135], v[32:35]
    v_mfma_f32_16x16x32_bf16 v[36:39], v[116:119], v[132:135], v[36:39]
    v_mfma_f32_16x16x32_bf16 v[52:55], v[116:119], v[136:139], v[52:55]
    v_mfma_f32_16x16x32_bf16 v[48:51], v[112:115], v[136:139], v[48:51]
    s_waitcnt lgkmcnt(0)
    s_barrier
    v_mfma_f32_16x16x32_bf16 v[40:43], v[120:123], v[132:135], v[40:43]
    ds_read_b128 v[100:103], v245 offset:0
    v_mfma_f32_16x16x32_bf16 v[56:59], v[120:123], v[136:139], v[56:59]
    ds_read_b64_tr_b16 v[80:81], v232 offset:16384
    v_mfma_f32_16x16x32_bf16 v[72:75], v[120:123], v[140:143], v[72:75]
    ds_read_b64_tr_b16 v[82:83], v232 offset:20480
    v_mfma_f32_16x16x32_bf16 v[68:71], v[116:119], v[140:143], v[68:71]
    ds_read_b64_tr_b16 v[84:85], v233 offset:16384
    v_mfma_f32_16x16x32_bf16 v[64:67], v[112:115], v[140:143], v[64:67]
    ds_read_b64_tr_b16 v[86:87], v233 offset:20480
    v_mfma_f32_16x16x32_bf16 v[44:47], v[124:127], v[132:135], v[44:47]
    ds_read_b128 v[104:107], v246 offset:0
    v_mfma_f32_16x16x32_bf16 v[60:63], v[124:127], v[136:139], v[60:63]
    ds_read_b64_tr_b16 v[88:89], v234 offset:16384
    v_mfma_f32_16x16x32_bf16 v[76:79], v[124:127], v[140:143], v[76:79]
    ds_read_b64_tr_b16 v[90:91], v234 offset:20480
    v_mfma_f32_16x16x32_bf16 v[28:31], v[124:127], v[128:131], v[28:31]
    ds_read_b128 v[108:111], v247 offset:0
    v_mfma_f32_16x16x32_bf16 v[24:27], v[120:123], v[128:131], v[24:27]
    ds_read_b64_tr_b16 v[92:93], v235 offset:16384
    v_mfma_f32_16x16x32_bf16 v[20:23], v[116:119], v[128:131], v[20:23]
    ds_read_b64_tr_b16 v[94:95], v235 offset:20480
    v_mfma_f32_16x16x32_bf16 v[16:19], v[112:115], v[128:131], v[16:19]
    ds_read_b128 v[96:99], v244 offset:0
L_s4:
    s_waitcnt lgkmcnt(6)
    v_mfma_f32_16x16x32_bf16 v[32:35], v[80:83], v[100:103], v[32:35]
    ds_read_b128 v[132:135], v245 offset:8192
    v_mfma_f32_16x16x32_bf16 v[36:39], v[84:87], v[100:103], v[36:39]
    ds_read_b64_tr_b16 v[112:113], v232 offset:24576
    v_mfma_f32_16x16x32_bf16 v[52:55], v[84:87], v[104:107], v[52:55]
    ds_read_b64_tr_b16 v[114:115], v232 offset:28672
    v_mfma_f32_16x16x32_bf16 v[48:51], v[80:83], v[104:107], v[48:51]
    ds_read_b64_tr_b16 v[116:117], v233 offset:24576
    s_waitcnt lgkmcnt(7)
    v_mfma_f32_16x16x32_bf16 v[40:43], v[88:91], v[100:103], v[40:43]
    ds_read_b64_tr_b16 v[118:119], v233 offset:28672
    v_mfma_f32_16x16x32_bf16 v[56:59], v[88:91], v[104:107], v[56:59]
    ds_read_b128 v[136:139], v246 offset:8192
    v_mfma_f32_16x16x32_bf16 v[72:75], v[88:91], v[108:111], v[72:75]
    ds_read_b64_tr_b16 v[120:121], v234 offset:24576
    v_mfma_f32_16x16x32_bf16 v[68:71], v[84:87], v[108:111], v[68:71]
    ds_read_b64_tr_b16 v[122:123], v234 offset:28672
    v_mfma_f32_16x16x32_bf16 v[64:67], v[80:83], v[108:111], v[64:67]
    ds_read_b128 v[140:143], v247 offset:8192
    s_waitcnt lgkmcnt(9)
    v_mfma_f32_16x16x32_bf16 v[44:47], v[92:95], v[100:103], v[44:47]
    ds_read_b64_tr_b16 v[124:125], v235 offset:24576
    v_mfma_f32_16x16x32_bf16 v[60:63], v[92:95], v[104:107], v[60:63]
    ds_read_b64_tr_b16 v[126:127], v235 offset:28672
    v_mfma_f32_16x16x32_bf16 v[76:79], v[92:95], v[108:111], v[76:79]
    ds_read_b128 v[128:131], v244 offset:8192
    v_mfma_f32_16x16x32_bf16 v[28:31], v[92:95], v[96:99], v[28:31]
    v_mfma_f32_16x16x32_bf16 v[24:27], v[88:91], v[96:99], v[24:27]
    v_mfma_f32_16x16x32_bf16 v[20:23], v[84:87], v[96:99], v[20:23]
    v_mfma_f32_16x16x32_bf16 v[16:19], v[80:83], v[96:99], v[16:19]
    s_waitcnt lgkmcnt(6)
    v_mfma_f32_16x16x32_bf16 v[32:35], v[112:115], v[132:135], v[32:35]
    v_mfma_f32_16x16x32_bf16 v[36:39], v[116:119], v[132:135], v[36:39]
    v_mfma_f32_16x16x32_bf16 v[52:55], v[116:119], v[136:139], v[52:55]
    v_mfma_f32_16x16x32_bf16 v[48:51], v[112:115], v[136:139], v[48:51]
    s_waitcnt lgkmcnt(0)
    s_barrier
    v_mfma_f32_16x16x32_bf16 v[40:43], v[120:123], v[132:135], v[40:43]
    ds_read_b128 v[100:103], v245 offset:16384
    v_mfma_f32_16x16x32_bf16 v[56:59], v[120:123], v[136:139], v[56:59]
    ds_read_b64_tr_b16 v[80:81], v240 offset:0
    v_mfma_f32_16x16x32_bf16 v[72:75], v[120:123], v[140:143], v[72:75]
    ds_read_b64_tr_b16 v[82:83], v240 offset:4096
    v_mfma_f32_16x16x32_bf16 v[68:71], v[116:119], v[140:143], v[68:71]
    ds_read_b64_tr_b16 v[84:85], v241 offset:0
    v_mfma_f32_16x16x32_bf16 v[64:67], v[112:115], v[140:143], v[64:67]
    ds_read_b64_tr_b16 v[86:87], v241 offset:4096
    v_mfma_f32_16x16x32_bf16 v[44:47], v[124:127], v[132:135], v[44:47]
    ds_read_b128 v[104:107], v246 offset:16384
    v_mfma_f32_16x16x32_bf16 v[60:63], v[124:127], v[136:139], v[60:63]
    ds_read_b64_tr_b16 v[88:89], v242 offset:0
    v_mfma_f32_16x16x32_bf16 v[76:79], v[124:127], v[140:143], v[76:79]
    ds_read_b64_tr_b16 v[90:91], v242 offset:4096
    v_mfma_f32_16x16x32_bf16 v[28:31], v[124:127], v[128:131], v[28:31]
    ds_read_b128 v[108:111], v247 offset:16384
    v_mfma_f32_16x16x32_bf16 v[24:27], v[120:123], v[128:131], v[24:27]
    ds_read_b64_tr_b16 v[92:93], v243 offset:0
    v_mfma_f32_16x16x32_bf16 v[20:23], v[116:119], v[128:131], v[20:23]
    ds_read_b64_tr_b16 v[94:95], v243 offset:4096
    v_mfma_f32_16x16x32_bf16 v[16:19], v[112:115], v[128:131], v[16:19]
    ds_read_b128 v[96:99], v244 offset:16384
L_s5:
    s_waitcnt lgkmcnt(6)
    v_mfma_f32_16x16x32_bf16 v[32:35], v[80:83], v[100:103], v[32:35]
    ds_read_b128 v[132:135], v245 offset:24576
    v_mfma_f32_16x16x32_bf16 v[36:39], v[84:87], v[100:103], v[36:39]
    ds_read_b64_tr_b16 v[112:113], v240 offset:8192
    v_mfma_f32_16x16x32_bf16 v[52:55], v[84:87], v[104:107], v[52:55]
    ds_read_b64_tr_b16 v[114:115], v240 offset:12288
    v_mfma_f32_16x16x32_bf16 v[48:51], v[80:83], v[104:107], v[48:51]
    ds_read_b64_tr_b16 v[116:117], v241 offset:8192
    s_waitcnt lgkmcnt(7)
    v_mfma_f32_16x16x32_bf16 v[40:43], v[88:91], v[100:103], v[40:43]
    ds_read_b64_tr_b16 v[118:119], v241 offset:12288
    v_mfma_f32_16x16x32_bf16 v[56:59], v[88:91], v[104:107], v[56:59]
    ds_read_b128 v[136:139], v246 offset:24576
    v_mfma_f32_16x16x32_bf16 v[72:75], v[88:91], v[108:111], v[72:75]
    ds_read_b64_tr_b16 v[120:121], v242 offset:8192
    v_mfma_f32_16x16x32_bf16 v[68:71], v[84:87], v[108:111], v[68:71]
    ds_read_b64_tr_b16 v[122:123], v242 offset:12288
    v_mfma_f32_16x16x32_bf16 v[64:67], v[80:83], v[108:111], v[64:67]
    ds_read_b128 v[140:143], v247 offset:24576
    s_waitcnt lgkmcnt(9)
    v_mfma_f32_16x16x32_bf16 v[44:47], v[92:95], v[100:103], v[44:47]
    ds_read_b64_tr_b16 v[124:125], v243 offset:8192
    v_mfma_f32_16x16x32_bf16 v[60:63], v[92:95], v[104:107], v[60:63]
    ds_read_b64_tr_b16 v[126:127], v243 offset:12288
    v_mfma_f32_16x16x32_bf16 v[76:79], v[92:95], v[108:111], v[76:79]
    ds_read_b128 v[128:131], v244 offset:24576
    v_mfma_f32_16x16x32_bf16 v[28:31], v[92:95], v[96:99], v[28:31]
    v_mfma_f32_16x16x32_bf16 v[24:27], v[88:91], v[96:99], v[24:27]
    v_mfma_f32_16x16x32_bf16 v[20:23], v[84:87], v[96:99], v[20:23]
    v_mfma_f32_16x16x32_bf16 v[16:19], v[80:83], v[96:99], v[16:19]
    s_waitcnt lgkmcnt(6)
    v_mfma_f32_16x16x32_bf16 v[32:35], v[112:115], v[132:135], v[32:35]
    v_mfma_f32_16x16x32_bf16 v[36:39], v[116:119], v[132:135], v[36:39]
    v_mfma_f32_16x16x32_bf16 v[52:55], v[116:119], v[136:139], v[52:55]
    v_mfma_f32_16x16x32_bf16 v[48:51], v[112:115], v[136:139], v[48:51]
    s_waitcnt lgkmcnt(0)
    s_barrier
    v_mfma_f32_16x16x32_bf16 v[40:43], v[120:123], v[132:135], v[40:43]
    ds_read_b128 v[100:103], v245 offset:32768
    v_mfma_f32_16x16x32_bf16 v[56:59], v[120:123], v[136:139], v[56:59]
    ds_read_b64_tr_b16 v[80:81], v240 offset:16384
    v_mfma_f32_16x16x32_bf16 v[72:75], v[120:123], v[140:143], v[72:75]
    ds_read_b64_tr_b16 v[82:83], v240 offset:20480
    v_mfma_f32_16x16x32_bf16 v[68:71], v[116:119], v[140:143], v[68:71]
    ds_read_b64_tr_b16 v[84:85], v241 offset:16384
    v_mfma_f32_16x16x32_bf16 v[64:67], v[112:115], v[140:143], v[64:67]
    ds_read_b64_tr_b16 v[86:87], v241 offset:20480
    v_mfma_f32_16x16x32_bf16 v[44:47], v[124:127], v[132:135], v[44:47]
    ds_read_b128 v[104:107], v246 offset:32768
    v_mfma_f32_16x16x32_bf16 v[60:63], v[124:127], v[136:139], v[60:63]
    ds_read_b64_tr_b16 v[88:89], v242 offset:16384
    v_mfma_f32_16x16x32_bf16 v[76:79], v[124:127], v[140:143], v[76:79]
    ds_read_b64_tr_b16 v[90:91], v242 offset:20480
    v_mfma_f32_16x16x32_bf16 v[28:31], v[124:127], v[128:131], v[28:31]
    ds_read_b128 v[108:111], v247 offset:32768
    v_mfma_f32_16x16x32_bf16 v[24:27], v[120:123], v[128:131], v[24:27]
    ds_read_b64_tr_b16 v[92:93], v243 offset:16384
    v_mfma_f32_16x16x32_bf16 v[20:23], v[116:119], v[128:131], v[20:23]
    ds_read_b64_tr_b16 v[94:95], v243 offset:20480
    v_mfma_f32_16x16x32_bf16 v[16:19], v[112:115], v[128:131], v[16:19]
    ds_read_b128 v[96:99], v244 offset:32768
L_s6:
    s_waitcnt lgkmcnt(6)
    v_mfma_f32_16x16x32_bf16 v[32:35], v[80:83], v[100:103], v[32:35]
    ds_read_b128 v[132:135], v245 offset:40960
    v_mfma_f32_16x16x32_bf16 v[36:39], v[84:87], v[100:103], v[36:39]
    ds_read_b64_tr_b16 v[112:113], v240 offset:24576
    v_mfma_f32_16x16x32_bf16 v[52:55], v[84:87], v[104:107], v[52:55]
    ds_read_b64_tr_b16 v[114:115], v240 offset:28672
    v_mfma_f32_16x16x32_bf16 v[48:51], v[80:83], v[104:107], v[48:51]
    ds_read_b64_tr_b16 v[116:117], v241 offset:24576
    s_waitcnt lgkmcnt(7)
    v_mfma_f32_16x16x32_bf16 v[40:43], v[88:91], v[100:103], v[40:43]
    ds_read_b64_tr_b16 v[118:119], v241 offset:28672
    v_mfma_f32_16x16x32_bf16 v[56:59], v[88:91], v[104:107], v[56:59]
    ds_read_b128 v[136:139], v246 offset:40960
    v_mfma_f32_16x16x32_bf16 v[72:75], v[88:91], v[108:111], v[72:75]
    ds_read_b64_tr_b16 v[120:121], v242 offset:24576
    v_mfma_f32_16x16x32_bf16 v[68:71], v[84:87], v[108:111], v[68:71]
    ds_read_b64_tr_b16 v[122:123], v242 offset:28672
    v_mfma_f32_16x16x32_bf16 v[64:67], v[80:83], v[108:111], v[64:67]
    ds_read_b128 v[140:143], v247 offset:40960
    s_waitcnt lgkmcnt(9)
    v_mfma_f32_16x16x32_bf16 v[44:47], v[92:95], v[100:103], v[44:47]
    ds_read_b64_tr_b16 v[124:125], v243 offset:24576
    v_mfma_f32_16x16x32_bf16 v[60:63], v[92:95], v[104:107], v[60:63]
    ds_read_b64_tr_b16 v[126:127], v243 offset:28672
    v_mfma_f32_16x16x32_bf16 v[76:79], v[92:95], v[108:111], v[76:79]
    ds_read_b128 v[128:131], v244 offset:40960
    v_mfma_f32_16x16x32_bf16 v[28:31], v[92:95], v[96:99], v[28:31]
    v_mfma_f32_16x16x32_bf16 v[24:27], v[88:91], v[96:99], v[24:27]
    v_mfma_f32_16x16x32_bf16 v[20:23], v[84:87], v[96:99], v[20:23]
    v_mfma_f32_16x16x32_bf16 v[16:19], v[80:83], v[96:99], v[16:19]
    s_waitcnt lgkmcnt(6)
    v_mfma_f32_16x16x32_bf16 v[32:35], v[112:115], v[132:135], v[32:35]
    v_mfma_f32_16x16x32_bf16 v[36:39], v[116:119], v[132:135], v[36:39]
    v_mfma_f32_16x16x32_bf16 v[52:55], v[116:119], v[136:139], v[52:55]
    v_mfma_f32_16x16x32_bf16 v[48:51], v[112:115], v[136:139], v[48:51]
    s_waitcnt lgkmcnt(0)
    s_barrier
    v_mfma_f32_16x16x32_bf16 v[40:43], v[120:123], v[132:135], v[40:43]
    ds_read_b128 v[100:103], v245 offset:49152
    v_mfma_f32_16x16x32_bf16 v[56:59], v[120:123], v[136:139], v[56:59]
    ds_read_b64_tr_b16 v[80:81], v240 offset:32768
    v_mfma_f32_16x16x32_bf16 v[72:75], v[120:123], v[140:143], v[72:75]
    ds_read_b64_tr_b16 v[82:83], v240 offset:36864
    v_mfma_f32_16x16x32_bf16 v[68:71], v[116:119], v[140:143], v[68:71]
    ds_read_b64_tr_b16 v[84:85], v241 offset:32768
    v_mfma_f32_16x16x32_bf16 v[64:67], v[112:115], v[140:143], v[64:67]
    ds_read_b64_tr_b16 v[86:87], v241 offset:36864
    v_mfma_f32_16x16x32_bf16 v[44:47], v[124:127], v[132:135], v[44:47]
    ds_read_b128 v[104:107], v246 offset:49152
    v_mfma_f32_16x16x32_bf16 v[60:63], v[124:127], v[136:139], v[60:63]
    ds_read_b64_tr_b16 v[88:89], v242 offset:32768
    v_mfma_f32_16x16x32_bf16 v[76:79], v[124:127], v[140:143], v[76:79]
    ds_read_b64_tr_b16 v[90:91], v242 offset:36864
    v_mfma_f32_16x16x32_bf16 v[28:31], v[124:127], v[128:131], v[28:31]
    ds_read_b128 v[108:111], v247 offset:49152
    v_mfma_f32_16x16x32_bf16 v[24:27], v[120:123], v[128:131], v[24:27]
    ds_read_b64_tr_b16 v[92:93], v243 offset:32768
    v_mfma_f32_16x16x32_bf16 v[20:23], v[116:119], v[128:131], v[20:23]
    ds_read_b64_tr_b16 v[94:95], v243 offset:36864
    v_mfma_f32_16x16x32_bf16 v[16:19], v[112:115], v[128:131], v[16:19]
    ds_read_b128 v[96:99], v244 offset:49152
L_s7:
    s_waitcnt lgkmcnt(6)
    v_mfma_f32_16x16x32_bf16 v[32:35], v[80:83], v[100:103], v[32:35]
    ds_read_b128 v[132:135], v245 offset:57344
    v_mfma_f32_16x16x32_bf16 v[36:39], v[84:87], v[100:103], v[36:39]
    ds_read_b64_tr_b16 v[112:113], v240 offset:40960
    v_mfma_f32_16x16x32_bf16 v[52:55], v[84:87], v[104:107], v[52:55]
    ds_read_b64_tr_b16 v[114:115], v240 offset:45056
    v_mfma_f32_16x16x32_bf16 v[48:51], v[80:83], v[104:107], v[48:51]
    ds_read_b64_tr_b16 v[116:117], v241 offset:40960
    s_waitcnt lgkmcnt(7)
    v_mfma_f32_16x16x32_bf16 v[40:43], v[88:91], v[100:103], v[40:43]
    ds_read_b64_tr_b16 v[118:119], v241 offset:45056
    v_mfma_f32_16x16x32_bf16 v[56:59], v[88:91], v[104:107], v[56:59]
    ds_read_b128 v[136:139], v246 offset:57344
    v_mfma_f32_16x16x32_bf16 v[72:75], v[88:91], v[108:111], v[72:75]
    ds_read_b64_tr_b16 v[120:121], v242 offset:40960
    v_mfma_f32_16x16x32_bf16 v[68:71], v[84:87], v[108:111], v[68:71]
    ds_read_b64_tr_b16 v[122:123], v242 offset:45056
    v_mfma_f32_16x16x32_bf16 v[64:67], v[80:83], v[108:111], v[64:67]
    ds_read_b128 v[140:143], v247 offset:57344
    s_waitcnt lgkmcnt(9)
    v_mfma_f32_16x16x32_bf16 v[44:47], v[92:95], v[100:103], v[44:47]
    ds_read_b64_tr_b16 v[124:125], v243 offset:40960
    v_mfma_f32_16x16x32_bf16 v[60:63], v[92:95], v[104:107], v[60:63]
    ds_read_b64_tr_b16 v[126:127], v243 offset:45056
    v_mfma_f32_16x16x32_bf16 v[76:79], v[92:95], v[108:111], v[76:79]
    ds_read_b128 v[128:131], v244 offset:57344
    v_mfma_f32_16x16x32_bf16 v[28:31], v[92:95], v[96:99], v[28:31]
    v_mfma_f32_16x16x32_bf16 v[24:27], v[88:91], v[96:99], v[24:27]
    v_mfma_f32_16x16x32_bf16 v[20:23], v[84:87], v[96:99], v[20:23]
    v_mfma_f32_16x16x32_bf16 v[16:19], v[80:83], v[96:99], v[16:19]
    s_waitcnt lgkmcnt(6)
    v_mfma_f32_16x16x32_bf16 v[32:35], v[112:115], v[132:135], v[32:35]
    v_mfma_f32_16x16x32_bf16 v[36:39], v[116:119], v[132:135], v[36:39]
    v_mfma_f32_16x16x32_bf16 v[52:55], v[116:119], v[136:139], v[52:55]
    v_mfma_f32_16x16x32_bf16 v[48:51], v[112:115], v[136:139], v[48:51]
    s_waitcnt lgkmcnt(0)
    s_barrier
    v_mfma_f32_16x16x32_bf16 v[40:43], v[120:123], v[132:135], v[40:43]
    ds_read_b128 v[100:103], v245 offset:0
    v_mfma_f32_16x16x32_bf16 v[56:59], v[120:123], v[136:139], v[56:59]
    ds_read_b64_tr_b16 v[80:81], v240 offset:49152
    v_mfma_f32_16x16x32_bf16 v[72:75], v[120:123], v[140:143], v[72:75]
    ds_read_b64_tr_b16 v[82:83], v240 offset:53248
    v_mfma_f32_16x16x32_bf16 v[68:71], v[116:119], v[140:143], v[68:71]
    ds_read_b64_tr_b16 v[84:85], v241 offset:49152
    v_mfma_f32_16x16x32_bf16 v[64:67], v[112:115], v[140:143], v[64:67]
    ds_read_b64_tr_b16 v[86:87], v241 offset:53248
    v_mfma_f32_16x16x32_bf16 v[44:47], v[124:127], v[132:135], v[44:47]
    ds_read_b128 v[104:107], v246 offset:0
    v_mfma_f32_16x16x32_bf16 v[60:63], v[124:127], v[136:139], v[60:63]
    ds_read_b64_tr_b16 v[88:89], v242 offset:49152
    v_mfma_f32_16x16x32_bf16 v[76:79], v[124:127], v[140:143], v[76:79]
    ds_read_b64_tr_b16 v[90:91], v242 offset:53248
    v_mfma_f32_16x16x32_bf16 v[28:31], v[124:127], v[128:131], v[28:31]
    ds_read_b128 v[108:111], v247 offset:0
    v_mfma_f32_16x16x32_bf16 v[24:27], v[120:123], v[128:131], v[24:27]
    ds_read_b64_tr_b16 v[92:93], v243 offset:49152
    v_mfma_f32_16x16x32_bf16 v[20:23], v[116:119], v[128:131], v[20:23]
    ds_read_b64_tr_b16 v[94:95], v243 offset:53248
    v_mfma_f32_16x16x32_bf16 v[16:19], v[112:115], v[128:131], v[16:19]
    ds_read_b128 v[96:99], v244 offset:0
L_s8:
    s_waitcnt lgkmcnt(6)
    v_mfma_f32_16x16x32_bf16 v[32:35], v[80:83], v[100:103], v[32:35]
    ds_read_b128 v[132:135], v245 offset:8192
    v_mfma_f32_16x16x32_bf16 v[36:39], v[84:87], v[100:103], v[36:39]
    ds_read_b64_tr_b16 v[112:113], v240 offset:57344
    v_mfma_f32_16x16x32_bf16 v[52:55], v[84:87], v[104:107], v[52:55]
    ds_read_b64_tr_b16 v[114:115], v240 offset:61440
    v_mfma_f32_16x16x32_bf16 v[48:51], v[80:83], v[104:107], v[48:51]
    ds_read_b64_tr_b16 v[116:117], v241 offset:57344
    s_waitcnt lgkmcnt(7)
    v_mfma_f32_16x16x32_bf16 v[40:43], v[88:91], v[100:103], v[40:43]
    ds_read_b64_tr_b16 v[118:119], v241 offset:61440
    v_mfma_f32_16x16x32_bf16 v[56:59], v[88:91], v[104:107], v[56:59]
    ds_read_b128 v[136:139], v246 offset:8192
    v_mfma_f32_16x16x32_bf16 v[72:75], v[88:91], v[108:111], v[72:75]
    ds_read_b64_tr_b16 v[120:121], v242 offset:57344
    v_mfma_f32_16x16x32_bf16 v[68:71], v[84:87], v[108:111], v[68:71]
    ds_read_b64_tr_b16 v[122:123], v242 offset:61440
    v_mfma_f32_16x16x32_bf16 v[64:67], v[80:83], v[108:111], v[64:67]
    ds_read_b128 v[140:143], v247 offset:8192
    s_waitcnt lgkmcnt(9)
    v_mfma_f32_16x16x32_bf16 v[44:47], v[92:95], v[100:103], v[44:47]
    ds_read_b64_tr_b16 v[124:125], v243 offset:57344
    v_mfma_f32_16x16x32_bf16 v[60:63], v[92:95], v[104:107], v[60:63]
    ds_read_b64_tr_b16 v[126:127], v243 offset:61440
    v_mfma_f32_16x16x32_bf16 v[76:79], v[92:95], v[108:111], v[76:79]
    ds_read_b128 v[128:131], v244 offset:8192
    v_mfma_f32_16x16x32_bf16 v[28:31], v[92:95], v[96:99], v[28:31]
    v_mfma_f32_16x16x32_bf16 v[24:27], v[88:91], v[96:99], v[24:27]
    v_mfma_f32_16x16x32_bf16 v[20:23], v[84:87], v[96:99], v[20:23]
    v_mfma_f32_16x16x32_bf16 v[16:19], v[80:83], v[96:99], v[16:19]
    s_waitcnt lgkmcnt(6)
    v_mfma_f32_16x16x32_bf16 v[32:35], v[112:115], v[132:135], v[32:35]
    v_mfma_f32_16x16x32_bf16 v[36:39], v[116:119], v[132:135], v[36:39]
    v_mfma_f32_16x16x32_bf16 v[52:55], v[116:119], v[136:139], v[52:55]
    v_mfma_f32_16x16x32_bf16 v[48:51], v[112:115], v[136:139], v[48:51]
    s_waitcnt lgkmcnt(0)
    s_barrier
    v_mfma_f32_16x16x32_bf16 v[40:43], v[120:123], v[132:135], v[40:43]
    ds_read_b128 v[100:103], v245 offset:16384
    v_mfma_f32_16x16x32_bf16 v[56:59], v[120:123], v[136:139], v[56:59]
    ds_read_b64_tr_b16 v[80:81], v232 offset:0
    v_mfma_f32_16x16x32_bf16 v[72:75], v[120:123], v[140:143], v[72:75]
    ds_read_b64_tr_b16 v[82:83], v232 offset:4096
    v_mfma_f32_16x16x32_bf16 v[68:71], v[116:119], v[140:143], v[68:71]
    ds_read_b64_tr_b16 v[84:85], v233 offset:0
    v_mfma_f32_16x16x32_bf16 v[64:67], v[112:115], v[140:143], v[64:67]
    ds_read_b64_tr_b16 v[86:87], v233 offset:4096
    v_mfma_f32_16x16x32_bf16 v[44:47], v[124:127], v[132:135], v[44:47]
    ds_read_b128 v[104:107], v246 offset:16384
    v_mfma_f32_16x16x32_bf16 v[60:63], v[124:127], v[136:139], v[60:63]
    ds_read_b64_tr_b16 v[88:89], v234 offset:0
    v_mfma_f32_16x16x32_bf16 v[76:79], v[124:127], v[140:143], v[76:79]
    ds_read_b64_tr_b16 v[90:91], v234 offset:4096
    v_mfma_f32_16x16x32_bf16 v[28:31], v[124:127], v[128:131], v[28:31]
    ds_read_b128 v[108:111], v247 offset:16384
    v_mfma_f32_16x16x32_bf16 v[24:27], v[120:123], v[128:131], v[24:27]
    ds_read_b64_tr_b16 v[92:93], v235 offset:0
    v_mfma_f32_16x16x32_bf16 v[20:23], v[116:119], v[128:131], v[20:23]
    ds_read_b64_tr_b16 v[94:95], v235 offset:4096
    v_mfma_f32_16x16x32_bf16 v[16:19], v[112:115], v[128:131], v[16:19]
    ds_read_b128 v[96:99], v244 offset:16384
L_s9:
    s_waitcnt lgkmcnt(6)
    v_mfma_f32_16x16x32_bf16 v[32:35], v[80:83], v[100:103], v[32:35]
    ds_read_b128 v[132:135], v245 offset:24576
    v_mfma_f32_16x16x32_bf16 v[36:39], v[84:87], v[100:103], v[36:39]
    ds_read_b64_tr_b16 v[112:113], v232 offset:8192
    v_mfma_f32_16x16x32_bf16 v[52:55], v[84:87], v[104:107], v[52:55]
    ds_read_b64_tr_b16 v[114:115], v232 offset:12288
    v_mfma_f32_16x16x32_bf16 v[48:51], v[80:83], v[104:107], v[48:51]
    ds_read_b64_tr_b16 v[116:117], v233 offset:8192
    s_waitcnt lgkmcnt(7)
    v_mfma_f32_16x16x32_bf16 v[40:43], v[88:91], v[100:103], v[40:43]
    ds_read_b64_tr_b16 v[118:119], v233 offset:12288
    v_mfma_f32_16x16x32_bf16 v[56:59], v[88:91], v[104:107], v[56:59]
    ds_read_b128 v[136:139], v246 offset:24576
    v_mfma_f32_16x16x32_bf16 v[72:75], v[88:91], v[108:111], v[72:75]
    ds_read_b64_tr_b16 v[120:121], v234 offset:8192
    v_mfma_f32_16x16x32_bf16 v[68:71], v[84:87], v[108:111], v[68:71]
    ds_read_b64_tr_b16 v[122:123], v234 offset:12288
    v_mfma_f32_16x16x32_bf16 v[64:67], v[80:83], v[108:111], v[64:67]
    ds_read_b128 v[140:143], v247 offset:24576
    s_waitcnt lgkmcnt(9)
    v_mfma_f32_16x16x32_bf16 v[44:47], v[92:95], v[100:103], v[44:47]
    ds_read_b64_tr_b16 v[124:125], v235 offset:8192
    v_mfma_f32_16x16x32_bf16 v[60:63], v[92:95], v[104:107], v[60:63]
    ds_read_b64_tr_b16 v[126:127], v235 offset:12288
    v_mfma_f32_16x16x32_bf16 v[76:79], v[92:95], v[108:111], v[76:79]
    ds_read_b128 v[128:131], v244 offset:24576
    v_mfma_f32_16x16x32_bf16 v[28:31], v[92:95], v[96:99], v[28:31]
    v_mfma_f32_16x16x32_bf16 v[24:27], v[88:91], v[96:99], v[24:27]
    v_mfma_f32_16x16x32_bf16 v[20:23], v[84:87], v[96:99], v[20:23]
    v_mfma_f32_16x16x32_bf16 v[16:19], v[80:83], v[96:99], v[16:19]
    s_waitcnt lgkmcnt(6)
    v_mfma_f32_16x16x32_bf16 v[32:35], v[112:115], v[132:135], v[32:35]
    v_mfma_f32_16x16x32_bf16 v[36:39], v[116:119], v[132:135], v[36:39]
    v_mfma_f32_16x16x32_bf16 v[52:55], v[116:119], v[136:139], v[52:55]
    v_mfma_f32_16x16x32_bf16 v[48:51], v[112:115], v[136:139], v[48:51]
    s_waitcnt lgkmcnt(0)
    s_barrier
    v_mfma_f32_16x16x32_bf16 v[40:43], v[120:123], v[132:135], v[40:43]
    ds_read_b128 v[100:103], v245 offset:32768
    v_mfma_f32_16x16x32_bf16 v[56:59], v[120:123], v[136:139], v[56:59]
    ds_read_b64_tr_b16 v[80:81], v232 offset:16384
    v_mfma_f32_16x16x32_bf16 v[72:75], v[120:123], v[140:143], v[72:75]
    ds_read_b64_tr_b16 v[82:83], v232 offset:20480
    v_mfma_f32_16x16x32_bf16 v[68:71], v[116:119], v[140:143], v[68:71]
    ds_read_b64_tr_b16 v[84:85], v233 offset:16384
    v_mfma_f32_16x16x32_bf16 v[64:67], v[112:115], v[140:143], v[64:67]
    ds_read_b64_tr_b16 v[86:87], v233 offset:20480
    v_mfma_f32_16x16x32_bf16 v[44:47], v[124:127], v[132:135], v[44:47]
    ds_read_b128 v[104:107], v246 offset:32768
    v_mfma_f32_16x16x32_bf16 v[60:63], v[124:127], v[136:139], v[60:63]
    ds_read_b64_tr_b16 v[88:89], v234 offset:16384
    v_mfma_f32_16x16x32_bf16 v[76:79], v[124:127], v[140:143], v[76:79]
    ds_read_b64_tr_b16 v[90:91], v234 offset:20480
    v_mfma_f32_16x16x32_bf16 v[28:31], v[124:127], v[128:131], v[28:31]
    ds_read_b128 v[108:111], v247 offset:32768
    v_mfma_f32_16x16x32_bf16 v[24:27], v[120:123], v[128:131], v[24:27]
    ds_read_b64_tr_b16 v[92:93], v235 offset:16384
    v_mfma_f32_16x16x32_bf16 v[20:23], v[116:119], v[128:131], v[20:23]
    ds_read_b64_tr_b16 v[94:95], v235 offset:20480
    v_mfma_f32_16x16x32_bf16 v[16:19], v[112:115], v[128:131], v[16:19]
    ds_read_b128 v[96:99], v244 offset:32768
L_s10:
    s_waitcnt lgkmcnt(6)
    v_mfma_f32_16x16x32_bf16 v[32:35], v[80:83], v[100:103], v[32:35]
    ds_read_b128 v[132:135], v245 offset:40960
    v_mfma_f32_16x16x32_bf16 v[36:39], v[84:87], v[100:103], v[36:39]
    ds_read_b64_tr_b16 v[112:113], v232 offset:24576
    v_mfma_f32_16x16x32_bf16 v[52:55], v[84:87], v[104:107], v[52:55]
    ds_read_b64_tr_b16 v[114:115], v232 offset:28672
    v_mfma_f32_16x16x32_bf16 v[48:51], v[80:83], v[104:107], v[48:51]
    ds_read_b64_tr_b16 v[116:117], v233 offset:24576
    s_waitcnt lgkmcnt(7)
    v_mfma_f32_16x16x32_bf16 v[40:43], v[88:91], v[100:103], v[40:43]
    ds_read_b64_tr_b16 v[118:119], v233 offset:28672
    v_mfma_f32_16x16x32_bf16 v[56:59], v[88:91], v[104:107], v[56:59]
    ds_read_b128 v[136:139], v246 offset:40960
    v_mfma_f32_16x16x32_bf16 v[72:75], v[88:91], v[108:111], v[72:75]
    ds_read_b64_tr_b16 v[120:121], v234 offset:24576
    v_mfma_f32_16x16x32_bf16 v[68:71], v[84:87], v[108:111], v[68:71]
    ds_read_b64_tr_b16 v[122:123], v234 offset:28672
    v_mfma_f32_16x16x32_bf16 v[64:67], v[80:83], v[108:111], v[64:67]
    ds_read_b128 v[140:143], v247 offset:40960
    s_waitcnt lgkmcnt(9)
    v_mfma_f32_16x16x32_bf16 v[44:47], v[92:95], v[100:103], v[44:47]
    ds_read_b64_tr_b16 v[124:125], v235 offset:24576
    v_mfma_f32_16x16x32_bf16 v[60:63], v[92:95], v[104:107], v[60:63]
    ds_read_b64_tr_b16 v[126:127], v235 offset:28672
    v_mfma_f32_16x16x32_bf16 v[76:79], v[92:95], v[108:111], v[76:79]
    ds_read_b128 v[128:131], v244 offset:40960
    v_mfma_f32_16x16x32_bf16 v[28:31], v[92:95], v[96:99], v[28:31]
    v_mfma_f32_16x16x32_bf16 v[24:27], v[88:91], v[96:99], v[24:27]
    v_mfma_f32_16x16x32_bf16 v[20:23], v[84:87], v[96:99], v[20:23]
    v_mfma_f32_16x16x32_bf16 v[16:19], v[80:83], v[96:99], v[16:19]
    s_waitcnt lgkmcnt(6)
    v_mfma_f32_16x16x32_bf16 v[32:35], v[112:115], v[132:135], v[32:35]
    v_mfma_f32_16x16x32_bf16 v[36:39], v[116:119], v[132:135], v[36:39]
    v_mfma_f32_16x16x32_bf16 v[52:55], v[116:119], v[136:139], v[52:55]
    v_mfma_f32_16x16x32_bf16 v[48:51], v[112:115], v[136:139], v[48:51]
    s_waitcnt lgkmcnt(0)
    s_barrier
    v_mfma_f32_16x16x32_bf16 v[40:43], v[120:123], v[132:135], v[40:43]
    ds_read_b128 v[100:103], v245 offset:49152
    v_mfma_f32_16x16x32_bf16 v[56:59], v[120:123], v[136:139], v[56:59]
    ds_read_b64_tr_b16 v[80:81], v240 offset:0
    v_mfma_f32_16x16x32_bf16 v[72:75], v[120:123], v[140:143], v[72:75]
    ds_read_b64_tr_b16 v[82:83], v240 offset:4096
    v_mfma_f32_16x16x32_bf16 v[68:71], v[116:119], v[140:143], v[68:71]
    ds_read_b64_tr_b16 v[84:85], v241 offset:0
    v_mfma_f32_16x16x32_bf16 v[64:67], v[112:115], v[140:143], v[64:67]
    ds_read_b64_tr_b16 v[86:87], v241 offset:4096
    v_mfma_f32_16x16x32_bf16 v[44:47], v[124:127], v[132:135], v[44:47]
    ds_read_b128 v[104:107], v246 offset:49152
    v_mfma_f32_16x16x32_bf16 v[60:63], v[124:127], v[136:139], v[60:63]
    ds_read_b64_tr_b16 v[88:89], v242 offset:0
    v_mfma_f32_16x16x32_bf16 v[76:79], v[124:127], v[140:143], v[76:79]
    ds_read_b64_tr_b16 v[90:91], v242 offset:4096
    v_mfma_f32_16x16x32_bf16 v[28:31], v[124:127], v[128:131], v[28:31]
    ds_read_b128 v[108:111], v247 offset:49152
    v_mfma_f32_16x16x32_bf16 v[24:27], v[120:123], v[128:131], v[24:27]
    ds_read_b64_tr_b16 v[92:93], v243 offset:0
    v_mfma_f32_16x16x32_bf16 v[20:23], v[116:119], v[128:131], v[20:23]
    ds_read_b64_tr_b16 v[94:95], v243 offset:4096
    v_mfma_f32_16x16x32_bf16 v[16:19], v[112:115], v[128:131], v[16:19]
    ds_read_b128 v[96:99], v244 offset:49152
L_s11:
    s_waitcnt lgkmcnt(6)
    v_mfma_f32_16x16x32_bf16 v[32:35], v[80:83], v[100:103], v[32:35]
    ds_read_b128 v[132:135], v245 offset:57344
    v_mfma_f32_16x16x32_bf16 v[36:39], v[84:87], v[100:103], v[36:39]
    ds_read_b64_tr_b16 v[112:113], v240 offset:8192
    v_mfma_f32_16x16x32_bf16 v[52:55], v[84:87], v[104:107], v[52:55]
    ds_read_b64_tr_b16 v[114:115], v240 offset:12288
    v_mfma_f32_16x16x32_bf16 v[48:51], v[80:83], v[104:107], v[48:51]
    ds_read_b64_tr_b16 v[116:117], v241 offset:8192
    s_waitcnt lgkmcnt(7)
    v_mfma_f32_16x16x32_bf16 v[40:43], v[88:91], v[100:103], v[40:43]
    ds_read_b64_tr_b16 v[118:119], v241 offset:12288
    v_mfma_f32_16x16x32_bf16 v[56:59], v[88:91], v[104:107], v[56:59]
    ds_read_b128 v[136:139], v246 offset:57344
    v_mfma_f32_16x16x32_bf16 v[72:75], v[88:91], v[108:111], v[72:75]
    ds_read_b64_tr_b16 v[120:121], v242 offset:8192
    v_mfma_f32_16x16x32_bf16 v[68:71], v[84:87], v[108:111], v[68:71]
    ds_read_b64_tr_b16 v[122:123], v242 offset:12288
    v_mfma_f32_16x16x32_bf16 v[64:67], v[80:83], v[108:111], v[64:67]
    ds_read_b128 v[140:143], v247 offset:57344
    s_waitcnt lgkmcnt(9)
    v_mfma_f32_16x16x32_bf16 v[44:47], v[92:95], v[100:103], v[44:47]
    ds_read_b64_tr_b16 v[124:125], v243 offset:8192
    v_mfma_f32_16x16x32_bf16 v[60:63], v[92:95], v[104:107], v[60:63]
    ds_read_b64_tr_b16 v[126:127], v243 offset:12288
    v_mfma_f32_16x16x32_bf16 v[76:79], v[92:95], v[108:111], v[76:79]
    ds_read_b128 v[128:131], v244 offset:57344
    v_mfma_f32_16x16x32_bf16 v[28:31], v[92:95], v[96:99], v[28:31]
    v_mfma_f32_16x16x32_bf16 v[24:27], v[88:91], v[96:99], v[24:27]
    v_mfma_f32_16x16x32_bf16 v[20:23], v[84:87], v[96:99], v[20:23]
    v_mfma_f32_16x16x32_bf16 v[16:19], v[80:83], v[96:99], v[16:19]
    s_waitcnt lgkmcnt(6)
    v_mfma_f32_16x16x32_bf16 v[32:35], v[112:115], v[132:135], v[32:35]
    v_mfma_f32_16x16x32_bf16 v[36:39], v[116:119], v[132:135], v[36:39]
    v_mfma_f32_16x16x32_bf16 v[52:55], v[116:119], v[136:139], v[52:55]
    v_mfma_f32_16x16x32_bf16 v[48:51], v[112:115], v[136:139], v[48:51]
    s_waitcnt lgkmcnt(0)
    s_barrier
    v_mfma_f32_16x16x32_bf16 v[40:43], v[120:123], v[132:135], v[40:43]
    v_mfma_f32_16x16x32_bf16 v[56:59], v[120:123], v[136:139], v[56:59]
    ds_read_b128 v[100:103], v245 offset:0
    v_mfma_f32_16x16x32_bf16 v[72:75], v[120:123], v[140:143], v[72:75]
    ds_read_b64_tr_b16 v[80:81], v240 offset:16384
    v_mfma_f32_16x16x32_bf16 v[68:71], v[116:119], v[140:143], v[68:71]
    ds_read_b64_tr_b16 v[82:83], v240 offset:20480
    v_mfma_f32_16x16x32_bf16 v[64:67], v[112:115], v[140:143], v[64:67]
    ds_read_b64_tr_b16 v[84:85], v241 offset:16384
    v_mfma_f32_16x16x32_bf16 v[44:47], v[124:127], v[132:135], v[44:47]
    ds_read_b64_tr_b16 v[86:87], v241 offset:20480
    v_mfma_f32_16x16x32_bf16 v[60:63], v[124:127], v[136:139], v[60:63]
    ds_read_b128 v[104:107], v246 offset:0
    v_mfma_f32_16x16x32_bf16 v[76:79], v[124:127], v[140:143], v[76:79]
    ds_read_b64_tr_b16 v[88:89], v242 offset:16384
    v_mfma_f32_16x16x32_bf16 v[28:31], v[124:127], v[128:131], v[28:31]
    ds_read_b64_tr_b16 v[90:91], v242 offset:20480
    v_mfma_f32_16x16x32_bf16 v[24:27], v[120:123], v[128:131], v[24:27]
    ds_read_b128 v[108:111], v247 offset:0
    v_mfma_f32_16x16x32_bf16 v[20:23], v[116:119], v[128:131], v[20:23]
    ds_read_b64_tr_b16 v[92:93], v243 offset:16384
    v_mfma_f32_16x16x32_bf16 v[16:19], v[112:115], v[128:131], v[16:19]
    ds_read_b64_tr_b16 v[94:95], v243 offset:20480
L_s12:
    s_waitcnt lgkmcnt(5)
    v_mfma_f32_16x16x32_bf16 v[32:35], v[80:83], v[100:103], v[32:35]
    ds_read_b128 v[132:135], v245 offset:8192
    v_mfma_f32_16x16x32_bf16 v[36:39], v[84:87], v[100:103], v[36:39]
    ds_read_b64_tr_b16 v[112:113], v240 offset:24576
    v_mfma_f32_16x16x32_bf16 v[52:55], v[84:87], v[104:107], v[52:55]
    ds_read_b64_tr_b16 v[114:115], v240 offset:28672
    v_mfma_f32_16x16x32_bf16 v[48:51], v[80:83], v[104:107], v[48:51]
    ds_read_b64_tr_b16 v[116:117], v241 offset:24576
    s_waitcnt lgkmcnt(6)
    v_mfma_f32_16x16x32_bf16 v[40:43], v[88:91], v[100:103], v[40:43]
    ds_read_b64_tr_b16 v[118:119], v241 offset:28672
    v_mfma_f32_16x16x32_bf16 v[56:59], v[88:91], v[104:107], v[56:59]
    ds_read_b128 v[136:139], v246 offset:8192
    v_mfma_f32_16x16x32_bf16 v[72:75], v[88:91], v[108:111], v[72:75]
    ds_read_b64_tr_b16 v[120:121], v242 offset:24576
    v_mfma_f32_16x16x32_bf16 v[68:71], v[84:87], v[108:111], v[68:71]
    ds_read_b64_tr_b16 v[122:123], v242 offset:28672
    v_mfma_f32_16x16x32_bf16 v[64:67], v[80:83], v[108:111], v[64:67]
    ds_read_b128 v[140:143], v247 offset:8192
    s_waitcnt lgkmcnt(9)
    v_mfma_f32_16x16x32_bf16 v[44:47], v[92:95], v[100:103], v[44:47]
    ds_read_b64_tr_b16 v[124:125], v243 offset:24576
    v_mfma_f32_16x16x32_bf16 v[60:63], v[92:95], v[104:107], v[60:63]
    ds_read_b64_tr_b16 v[126:127], v243 offset:28672
    v_mfma_f32_16x16x32_bf16 v[76:79], v[92:95], v[108:111], v[76:79]
    s_waitcnt lgkmcnt(5)
    v_mfma_f32_16x16x32_bf16 v[32:35], v[112:115], v[132:135], v[32:35]
    v_mfma_f32_16x16x32_bf16 v[36:39], v[116:119], v[132:135], v[36:39]
    v_mfma_f32_16x16x32_bf16 v[52:55], v[116:119], v[136:139], v[52:55]
    s_waitcnt lgkmcnt(0)
    s_barrier
    v_mfma_f32_16x16x32_bf16 v[48:51], v[112:115], v[136:139], v[48:51]
    ds_read_b128 v[100:103], v245 offset:16384
    v_mfma_f32_16x16x32_bf16 v[40:43], v[120:123], v[132:135], v[40:43]
    ds_read_b64_tr_b16 v[80:81], v240 offset:32768
    v_mfma_f32_16x16x32_bf16 v[56:59], v[120:123], v[136:139], v[56:59]
    ds_read_b64_tr_b16 v[82:83], v240 offset:36864
    v_mfma_f32_16x16x32_bf16 v[72:75], v[120:123], v[140:143], v[72:75]
    ds_read_b64_tr_b16 v[84:85], v241 offset:32768
    v_mfma_f32_16x16x32_bf16 v[68:71], v[116:119], v[140:143], v[68:71]
    ds_read_b64_tr_b16 v[86:87], v241 offset:36864
    ds_read_b128 v[104:107], v246 offset:16384
    v_mfma_f32_16x16x32_bf16 v[64:67], v[112:115], v[140:143], v[64:67]
    ds_read_b64_tr_b16 v[88:89], v242 offset:32768
    v_mfma_f32_16x16x32_bf16 v[44:47], v[124:127], v[132:135], v[44:47]
    ds_read_b64_tr_b16 v[90:91], v242 offset:36864
    v_mfma_f32_16x16x32_bf16 v[60:63], v[124:127], v[136:139], v[60:63]
    ds_read_b128 v[108:111], v247 offset:16384
    v_mfma_f32_16x16x32_bf16 v[76:79], v[124:127], v[140:143], v[76:79]
    ds_read_b64_tr_b16 v[92:93], v243 offset:32768
    ds_read_b64_tr_b16 v[94:95], v243 offset:36864
L_s13:
    s_waitcnt lgkmcnt(5)
    v_mfma_f32_16x16x32_bf16 v[32:35], v[80:83], v[100:103], v[32:35]
    ds_read_b128 v[132:135], v245 offset:24576
    v_mfma_f32_16x16x32_bf16 v[36:39], v[84:87], v[100:103], v[36:39]
    ds_read_b64_tr_b16 v[112:113], v240 offset:40960
    v_mfma_f32_16x16x32_bf16 v[52:55], v[84:87], v[104:107], v[52:55]
    ds_read_b64_tr_b16 v[114:115], v240 offset:45056
    v_mfma_f32_16x16x32_bf16 v[48:51], v[80:83], v[104:107], v[48:51]
    ds_read_b64_tr_b16 v[116:117], v241 offset:40960
    s_waitcnt lgkmcnt(6)
    v_mfma_f32_16x16x32_bf16 v[40:43], v[88:91], v[100:103], v[40:43]
    ds_read_b64_tr_b16 v[118:119], v241 offset:45056
    v_mfma_f32_16x16x32_bf16 v[56:59], v[88:91], v[104:107], v[56:59]
    ds_read_b128 v[136:139], v246 offset:24576
    v_mfma_f32_16x16x32_bf16 v[72:75], v[88:91], v[108:111], v[72:75]
    ds_read_b64_tr_b16 v[120:121], v242 offset:40960
    v_mfma_f32_16x16x32_bf16 v[68:71], v[84:87], v[108:111], v[68:71]
    ds_read_b64_tr_b16 v[122:123], v242 offset:45056
    v_mfma_f32_16x16x32_bf16 v[64:67], v[80:83], v[108:111], v[64:67]
    ds_read_b128 v[140:143], v247 offset:24576
    s_waitcnt lgkmcnt(9)
    v_mfma_f32_16x16x32_bf16 v[44:47], v[92:95], v[100:103], v[44:47]
    ds_read_b64_tr_b16 v[124:125], v243 offset:40960
    v_mfma_f32_16x16x32_bf16 v[60:63], v[92:95], v[104:107], v[60:63]
    ds_read_b64_tr_b16 v[126:127], v243 offset:45056
    v_mfma_f32_16x16x32_bf16 v[76:79], v[92:95], v[108:111], v[76:79]
    s_waitcnt lgkmcnt(5)
    v_mfma_f32_16x16x32_bf16 v[32:35], v[112:115], v[132:135], v[32:35]
    v_mfma_f32_16x16x32_bf16 v[36:39], v[116:119], v[132:135], v[36:39]
    v_mfma_f32_16x16x32_bf16 v[52:55], v[116:119], v[136:139], v[52:55]
    s_waitcnt lgkmcnt(0)
    s_barrier
    v_mfma_f32_16x16x32_bf16 v[48:51], v[112:115], v[136:139], v[48:51]
    ds_read_b128 v[100:103], v245 offset:32768
    v_mfma_f32_16x16x32_bf16 v[40:43], v[120:123], v[132:135], v[40:43]
    ds_read_b64_tr_b16 v[80:81], v240 offset:49152
    v_mfma_f32_16x16x32_bf16 v[56:59], v[120:123], v[136:139], v[56:59]
    ds_read_b64_tr_b16 v[82:83], v240 offset:53248
    v_mfma_f32_16x16x32_bf16 v[72:75], v[120:123], v[140:143], v[72:75]
    ds_read_b64_tr_b16 v[84:85], v241 offset:49152
    v_mfma_f32_16x16x32_bf16 v[68:71], v[116:119], v[140:143], v[68:71]
    ds_read_b64_tr_b16 v[86:87], v241 offset:53248
    ds_read_b128 v[104:107], v246 offset:32768
    v_mfma_f32_16x16x32_bf16 v[64:67], v[112:115], v[140:143], v[64:67]
    ds_read_b64_tr_b16 v[88:89], v242 offset:49152
    v_mfma_f32_16x16x32_bf16 v[44:47], v[124:127], v[132:135], v[44:47]
    ds_read_b64_tr_b16 v[90:91], v242 offset:53248
    v_mfma_f32_16x16x32_bf16 v[60:63], v[124:127], v[136:139], v[60:63]
    ds_read_b128 v[108:111], v247 offset:32768
    v_mfma_f32_16x16x32_bf16 v[76:79], v[124:127], v[140:143], v[76:79]
    ds_read_b64_tr_b16 v[92:93], v243 offset:49152
    ds_read_b64_tr_b16 v[94:95], v243 offset:53248
L_s14:
    s_waitcnt lgkmcnt(5)
    v_mfma_f32_16x16x32_bf16 v[32:35], v[80:83], v[100:103], v[32:35]
    ds_read_b128 v[132:135], v245 offset:40960
    v_mfma_f32_16x16x32_bf16 v[36:39], v[84:87], v[100:103], v[36:39]
    ds_read_b64_tr_b16 v[112:113], v240 offset:57344
    v_mfma_f32_16x16x32_bf16 v[52:55], v[84:87], v[104:107], v[52:55]
    ds_read_b64_tr_b16 v[114:115], v240 offset:61440
    v_mfma_f32_16x16x32_bf16 v[48:51], v[80:83], v[104:107], v[48:51]
    ds_read_b64_tr_b16 v[116:117], v241 offset:57344
    s_waitcnt lgkmcnt(6)
    v_mfma_f32_16x16x32_bf16 v[40:43], v[88:91], v[100:103], v[40:43]
    ds_read_b64_tr_b16 v[118:119], v241 offset:61440
    v_mfma_f32_16x16x32_bf16 v[56:59], v[88:91], v[104:107], v[56:59]
    ds_read_b128 v[136:139], v246 offset:40960
    v_mfma_f32_16x16x32_bf16 v[72:75], v[88:91], v[108:111], v[72:75]
    ds_read_b64_tr_b16 v[120:121], v242 offset:57344
    v_mfma_f32_16x16x32_bf16 v[68:71], v[84:87], v[108:111], v[68:71]
    ds_read_b64_tr_b16 v[122:123], v242 offset:61440
    v_mfma_f32_16x16x32_bf16 v[64:67], v[80:83], v[108:111], v[64:67]
    ds_read_b128 v[140:143], v247 offset:40960
    s_waitcnt lgkmcnt(9)
    v_mfma_f32_16x16x32_bf16 v[44:47], v[92:95], v[100:103], v[44:47]
    ds_read_b64_tr_b16 v[124:125], v243 offset:57344
    v_mfma_f32_16x16x32_bf16 v[60:63], v[92:95], v[104:107], v[60:63]
    ds_read_b64_tr_b16 v[126:127], v243 offset:61440
    v_mfma_f32_16x16x32_bf16 v[76:79], v[92:95], v[108:111], v[76:79]
    s_waitcnt lgkmcnt(5)
    v_mfma_f32_16x16x32_bf16 v[32:35], v[112:115], v[132:135], v[32:35]
    v_mfma_f32_16x16x32_bf16 v[36:39], v[116:119], v[132:135], v[36:39]
    v_mfma_f32_16x16x32_bf16 v[52:55], v[116:119], v[136:139], v[52:55]
    s_waitcnt lgkmcnt(0)
    s_barrier
    v_mfma_f32_16x16x32_bf16 v[48:51], v[112:115], v[136:139], v[48:51]
    ds_read_b128 v[100:103], v245 offset:49152
    v_mfma_f32_16x16x32_bf16 v[40:43], v[120:123], v[132:135], v[40:43]
    ds_read_b64_tr_b16 v[80:81], v232 offset:0
    v_mfma_f32_16x16x32_bf16 v[56:59], v[120:123], v[136:139], v[56:59]
    ds_read_b64_tr_b16 v[82:83], v232 offset:4096
    v_mfma_f32_16x16x32_bf16 v[72:75], v[120:123], v[140:143], v[72:75]
    ds_read_b64_tr_b16 v[84:85], v233 offset:0
    v_mfma_f32_16x16x32_bf16 v[68:71], v[116:119], v[140:143], v[68:71]
    ds_read_b64_tr_b16 v[86:87], v233 offset:4096
    ds_read_b128 v[104:107], v246 offset:49152
    v_mfma_f32_16x16x32_bf16 v[64:67], v[112:115], v[140:143], v[64:67]
    ds_read_b64_tr_b16 v[88:89], v234 offset:0
    v_mfma_f32_16x16x32_bf16 v[44:47], v[124:127], v[132:135], v[44:47]
    ds_read_b64_tr_b16 v[90:91], v234 offset:4096
    v_mfma_f32_16x16x32_bf16 v[60:63], v[124:127], v[136:139], v[60:63]
    ds_read_b128 v[108:111], v247 offset:49152
    v_mfma_f32_16x16x32_bf16 v[76:79], v[124:127], v[140:143], v[76:79]
    ds_read_b64_tr_b16 v[92:93], v235 offset:0
    ds_read_b64_tr_b16 v[94:95], v235 offset:4096
L_s15:
    s_waitcnt lgkmcnt(5)
    v_mfma_f32_16x16x32_bf16 v[32:35], v[80:83], v[100:103], v[32:35]
    ds_read_b128 v[132:135], v245 offset:57344
    v_mfma_f32_16x16x32_bf16 v[36:39], v[84:87], v[100:103], v[36:39]
    ds_read_b64_tr_b16 v[112:113], v232 offset:8192
    v_mfma_f32_16x16x32_bf16 v[52:55], v[84:87], v[104:107], v[52:55]
    ds_read_b64_tr_b16 v[114:115], v232 offset:12288
    v_mfma_f32_16x16x32_bf16 v[48:51], v[80:83], v[104:107], v[48:51]
    ds_read_b64_tr_b16 v[116:117], v233 offset:8192
    s_waitcnt lgkmcnt(6)
    v_mfma_f32_16x16x32_bf16 v[40:43], v[88:91], v[100:103], v[40:43]
    ds_read_b64_tr_b16 v[118:119], v233 offset:12288
    v_mfma_f32_16x16x32_bf16 v[56:59], v[88:91], v[104:107], v[56:59]
    ds_read_b128 v[136:139], v246 offset:57344
    v_mfma_f32_16x16x32_bf16 v[72:75], v[88:91], v[108:111], v[72:75]
    ds_read_b64_tr_b16 v[120:121], v234 offset:8192
    v_mfma_f32_16x16x32_bf16 v[68:71], v[84:87], v[108:111], v[68:71]
    ds_read_b64_tr_b16 v[122:123], v234 offset:12288
    v_mfma_f32_16x16x32_bf16 v[64:67], v[80:83], v[108:111], v[64:67]
    ds_read_b128 v[140:143], v247 offset:57344
    s_waitcnt lgkmcnt(9)
    v_mfma_f32_16x16x32_bf16 v[44:47], v[92:95], v[100:103], v[44:47]
    ds_read_b64_tr_b16 v[124:125], v235 offset:8192
    v_mfma_f32_16x16x32_bf16 v[60:63], v[92:95], v[104:107], v[60:63]
    ds_read_b64_tr_b16 v[126:127], v235 offset:12288
    v_mfma_f32_16x16x32_bf16 v[76:79], v[92:95], v[108:111], v[76:79]
L_tail2:
    s_waitcnt lgkmcnt(8)
    v_mfma_f32_16x16x32_bf16 v[32:35], v[112:115], v[132:135], v[32:35]
    s_waitcnt lgkmcnt(6)
    v_mfma_f32_16x16x32_bf16 v[36:39], v[116:119], v[132:135], v[36:39]
    s_waitcnt lgkmcnt(3)
    v_mfma_f32_16x16x32_bf16 v[40:43], v[120:123], v[132:135], v[40:43]
    s_waitcnt lgkmcnt(0)
    v_mfma_f32_16x16x32_bf16 v[44:47], v[124:127], v[132:135], v[44:47]
    v_mfma_f32_16x16x32_bf16 v[48:51], v[112:115], v[136:139], v[48:51]
    v_mfma_f32_16x16x32_bf16 v[52:55], v[116:119], v[136:139], v[52:55]
    v_mfma_f32_16x16x32_bf16 v[56:59], v[120:123], v[136:139], v[56:59]
    v_mfma_f32_16x16x32_bf16 v[60:63], v[124:127], v[136:139], v[60:63]
    v_mfma_f32_16x16x32_bf16 v[64:67], v[112:115], v[140:143], v[64:67]
    v_cvt_pk_bf16_f32 v32, v32, v33
    v_cvt_pk_bf16_f32 v33, v34, v35
    v_cvt_pk_bf16_f32 v34, v36, v37
    v_mfma_f32_16x16x32_bf16 v[68:71], v[116:119], v[140:143], v[68:71]
    v_cvt_pk_bf16_f32 v35, v38, v39
    buffer_store_dwordx4 v[32:35], v9, s[52:55], s36 offen offset:0 sc1
    v_cvt_pk_bf16_f32 v40, v40, v41
    v_mfma_f32_16x16x32_bf16 v[72:75], v[120:123], v[140:143], v[72:75]
    v_cvt_pk_bf16_f32 v41, v42, v43
    v_cvt_pk_bf16_f32 v42, v44, v45
    v_cvt_pk_bf16_f32 v43, v46, v47
    v_mfma_f32_16x16x32_bf16 v[76:79], v[124:127], v[140:143], v[76:79]
    buffer_store_dwordx4 v[40:43], v9, s[52:55], s36 offen offset:1024 sc1
    v_cvt_pk_bf16_f32 v48, v48, v49
    v_cvt_pk_bf16_f32 v49, v50, v51
    v_cvt_pk_bf16_f32 v50, v52, v53
    v_cvt_pk_bf16_f32 v51, v54, v55
    buffer_store_dwordx4 v[48:51], v9, s[52:55], s37 offen offset:0 sc1
    v_cvt_pk_bf16_f32 v56, v56, v57
    v_cvt_pk_bf16_f32 v57, v58, v59
    v_cvt_pk_bf16_f32 v58, v60, v61
    v_cvt_pk_bf16_f32 v59, v62, v63
    buffer_store_dwordx4 v[56:59], v9, s[52:55], s37 offen offset:1024 sc1
    v_cvt_pk_bf16_f32 v64, v64, v65
    v_cvt_pk_bf16_f32 v65, v66, v67
    v_cvt_pk_bf16_f32 v66, v68, v69
    v_cvt_pk_bf16_f32 v67, v70, v71
    buffer_store_dwordx4 v[64:67], v9, s[52:55], s38 offen offset:0 sc1
    v_cvt_pk_bf16_f32 v72, v72, v73
    v_cvt_pk_bf16_f32 v73, v74, v75
    v_cvt_pk_bf16_f32 v74, v76, v77
    v_cvt_pk_bf16_f32 v75, v78, v79
    buffer_store_dwordx4 v[72:75], v9, s[52:55], s38 offen offset:1024 sc1
    ds_read_b128 v[96:99], v244 offset:0
    ds_read_b64_tr_b16 v[80:81], v240 offset:16384
    ds_read_b64_tr_b16 v[82:83], v240 offset:20480
    ds_read_b64_tr_b16 v[84:85], v241 offset:16384
    ds_read_b64_tr_b16 v[86:87], v241 offset:20480
    ds_read_b64_tr_b16 v[88:89], v242 offset:16384
    ds_read_b64_tr_b16 v[90:91], v242 offset:20480
    ds_read_b64_tr_b16 v[92:93], v243 offset:16384
    ds_read_b64_tr_b16 v[94:95], v243 offset:20480
    ds_read_b128 v[128:131], v244 offset:8192
    ds_read_b64_tr_b16 v[112:113], v240 offset:24576
    ds_read_b64_tr_b16 v[114:115], v240 offset:28672
    s_waitcnt lgkmcnt(8)
    v_mfma_f32_16x16x32_bf16 v[16:19], v[80:83], v[96:99], v[16:19]
    ds_read_b64_tr_b16 v[116:117], v241 offset:24576
    s_waitcnt lgkmcnt(8)
    v_mfma_f32_16x16x32_bf16 v[20:23], v[84:87], v[96:99], v[20:23]
    ds_read_b64_tr_b16 v[118:119], v241 offset:28672
    ds_read_b64_tr_b16 v[120:121], v242 offset:24576
    s_waitcnt lgkmcnt(8)
    v_mfma_f32_16x16x32_bf16 v[24:27], v[88:91], v[96:99], v[24:27]
    ds_read_b64_tr_b16 v[122:123], v242 offset:28672
    s_waitcnt lgkmcnt(7)
    v_mfma_f32_16x16x32_bf16 v[28:31], v[92:95], v[96:99], v[28:31]
    ds_read_b64_tr_b16 v[124:125], v243 offset:24576
    ds_read_b64_tr_b16 v[126:127], v243 offset:28672
    ds_read_b128 v[96:99], v244 offset:16384
    ds_read_b64_tr_b16 v[80:81], v240 offset:32768
    ds_read_b64_tr_b16 v[82:83], v240 offset:36864
    s_waitcnt lgkmcnt(8)
    v_mfma_f32_16x16x32_bf16 v[16:19], v[112:115], v[128:131], v[16:19]
    ds_read_b64_tr_b16 v[84:85], v241 offset:32768
    s_waitcnt lgkmcnt(8)
    v_mfma_f32_16x16x32_bf16 v[20:23], v[116:119], v[128:131], v[20:23]
    ds_read_b64_tr_b16 v[86:87], v241 offset:36864
    ds_read_b64_tr_b16 v[88:89], v242 offset:32768
    s_waitcnt lgkmcnt(8)
    v_mfma_f32_16x16x32_bf16 v[24:27], v[120:123], v[128:131], v[24:27]
    ds_read_b64_tr_b16 v[90:91], v242 offset:36864
    s_waitcnt lgkmcnt(7)
    v_mfma_f32_16x16x32_bf16 v[28:31], v[124:127], v[128:131], v[28:31]
    ds_read_b64_tr_b16 v[92:93], v243 offset:32768
    ds_read_b64_tr_b16 v[94:95], v243 offset:36864
    ds_read_b128 v[128:131], v244 offset:24576
    ds_read_b64_tr_b16 v[112:113], v240 offset:40960
    ds_read_b64_tr_b16 v[114:115], v240 offset:45056
    s_waitcnt lgkmcnt(8)
    v_mfma_f32_16x16x32_bf16 v[16:19], v[80:83], v[96:99], v[16:19]
    ds_read_b64_tr_b16 v[116:117], v241 offset:40960
    s_waitcnt lgkmcnt(8)
    v_mfma_f32_16x16x32_bf16 v[20:23], v[84:87], v[96:99], v[20:23]
    ds_read_b64_tr_b16 v[118:119], v241 offset:45056
    ds_read_b64_tr_b16 v[120:121], v242 offset:40960
    s_waitcnt lgkmcnt(8)
    v_mfma_f32_16x16x32_bf16 v[24:27], v[88:91], v[96:99], v[24:27]
    ds_read_b64_tr_b16 v[122:123], v242 offset:45056
    s_waitcnt lgkmcnt(7)
    v_mfma_f32_16x16x32_bf16 v[28:31], v[92:95], v[96:99], v[28:31]
    ds_read_b64_tr_b16 v[124:125], v243 offset:40960
    ds_read_b64_tr_b16 v[126:127], v243 offset:45056
    ds_read_b128 v[96:99], v244 offset:32768
    ds_read_b64_tr_b16 v[80:81], v240 offset:49152
    ds_read_b64_tr_b16 v[82:83], v240 offset:53248
    s_waitcnt lgkmcnt(8)
    v_mfma_f32_16x16x32_bf16 v[16:19], v[112:115], v[128:131], v[16:19]
    ds_read_b64_tr_b16 v[84:85], v241 offset:49152
    s_waitcnt lgkmcnt(8)
    v_mfma_f32_16x16x32_bf16 v[20:23], v[116:119], v[128:131], v[20:23]
    ds_read_b64_tr_b16 v[86:87], v241 offset:53248
    ds_read_b64_tr_b16 v[88:89], v242 offset:49152
    s_waitcnt lgkmcnt(8)
    v_mfma_f32_16x16x32_bf16 v[24:27], v[120:123], v[128:131], v[24:27]
    ds_read_b64_tr_b16 v[90:91], v242 offset:53248
    s_waitcnt lgkmcnt(7)
    v_mfma_f32_16x16x32_bf16 v[28:31], v[124:127], v[128:131], v[28:31]
    ds_read_b64_tr_b16 v[92:93], v243 offset:49152
    ds_read_b64_tr_b16 v[94:95], v243 offset:53248
    ds_read_b128 v[128:131], v244 offset:40960
    ds_read_b64_tr_b16 v[112:113], v240 offset:57344
    ds_read_b64_tr_b16 v[114:115], v240 offset:61440
    s_waitcnt lgkmcnt(8)
    v_mfma_f32_16x16x32_bf16 v[16:19], v[80:83], v[96:99], v[16:19]
    ds_read_b64_tr_b16 v[116:117], v241 offset:57344
    s_waitcnt lgkmcnt(8)
    v_mfma_f32_16x16x32_bf16 v[20:23], v[84:87], v[96:99], v[20:23]
    ds_read_b64_tr_b16 v[118:119], v241 offset:61440
    ds_read_b64_tr_b16 v[120:121], v242 offset:57344
    s_waitcnt lgkmcnt(8)
    v_mfma_f32_16x16x32_bf16 v[24:27], v[88:91], v[96:99], v[24:27]
    ds_read_b64_tr_b16 v[122:123], v242 offset:61440
    s_waitcnt lgkmcnt(7)
    v_mfma_f32_16x16x32_bf16 v[28:31], v[92:95], v[96:99], v[28:31]
    ds_read_b64_tr_b16 v[124:125], v243 offset:57344
    ds_read_b64_tr_b16 v[126:127], v243 offset:61440
    ds_read_b128 v[96:99], v244 offset:49152
    ds_read_b64_tr_b16 v[80:81], v232 offset:0
    ds_read_b64_tr_b16 v[82:83], v232 offset:4096
    s_waitcnt lgkmcnt(8)
    v_mfma_f32_16x16x32_bf16 v[16:19], v[112:115], v[128:131], v[16:19]
    ds_read_b64_tr_b16 v[84:85], v233 offset:0
    s_waitcnt lgkmcnt(8)
    v_mfma_f32_16x16x32_bf16 v[20:23], v[116:119], v[128:131], v[20:23]
    ds_read_b64_tr_b16 v[86:87], v233 offset:4096
    ds_read_b64_tr_b16 v[88:89], v234 offset:0
    s_waitcnt lgkmcnt(8)
    v_mfma_f32_16x16x32_bf16 v[24:27], v[120:123], v[128:131], v[24:27]
    ds_read_b64_tr_b16 v[90:91], v234 offset:4096
    s_waitcnt lgkmcnt(7)
    v_mfma_f32_16x16x32_bf16 v[28:31], v[124:127], v[128:131], v[28:31]
    ds_read_b64_tr_b16 v[92:93], v235 offset:0
    ds_read_b64_tr_b16 v[94:95], v235 offset:4096
    ds_read_b128 v[128:131], v244 offset:57344
    ds_read_b64_tr_b16 v[112:113], v232 offset:8192
    ds_read_b64_tr_b16 v[114:115], v232 offset:12288
    s_waitcnt lgkmcnt(8)
    v_mfma_f32_16x16x32_bf16 v[16:19], v[80:83], v[96:99], v[16:19]
    ds_read_b64_tr_b16 v[116:117], v233 offset:8192
    s_waitcnt lgkmcnt(8)
    v_mfma_f32_16x16x32_bf16 v[20:23], v[84:87], v[96:99], v[20:23]
    ds_read_b64_tr_b16 v[118:119], v233 offset:12288
    ds_read_b64_tr_b16 v[120:121], v234 offset:8192
    s_waitcnt lgkmcnt(8)
    v_mfma_f32_16x16x32_bf16 v[24:27], v[88:91], v[96:99], v[24:27]
    ds_read_b64_tr_b16 v[122:123], v234 offset:12288
    s_waitcnt lgkmcnt(7)
    v_mfma_f32_16x16x32_bf16 v[28:31], v[92:95], v[96:99], v[28:31]
    ds_read_b64_tr_b16 v[124:125], v235 offset:8192
    ds_read_b64_tr_b16 v[126:127], v235 offset:12288
    s_waitcnt lgkmcnt(6)
    v_mfma_f32_16x16x32_bf16 v[16:19], v[112:115], v[128:131], v[16:19]
    s_waitcnt lgkmcnt(4)
    v_mfma_f32_16x16x32_bf16 v[20:23], v[116:119], v[128:131], v[20:23]
    s_waitcnt lgkmcnt(2)
    v_mfma_f32_16x16x32_bf16 v[24:27], v[120:123], v[128:131], v[24:27]
    s_waitcnt lgkmcnt(0)
    v_mfma_f32_16x16x32_bf16 v[28:31], v[124:127], v[128:131], v[28:31]
    s_waitcnt vmcnt(0)
    s_mov_b64 exec, 1
    buffer_store_dwordx2 v[254:255], v253, s[52:55], s42 offen sc1
    s_lshl_b32 s14, 1, s10
    s_xor_b32 s14, s14, 15
    s_mov_b32 s15, 0
    s_mov_b32 s9, 16777216
    s_mov_b64 exec, s[14:15]
L_pf2:
    buffer_load_dwordx2 v[250:251], v248, s[52:55], s40 offen sc1
    s_waitcnt vmcnt(0)
    v_cmp_gt_u64 vcc, s[96:97], v[250:251]
    v_cmp_lt_u64 s[100:101], s[98:99], v[250:251]
    s_nop 0
    s_or_b64 vcc, vcc, s[100:101]
    s_cbranch_scc0 L_pf2_ok
    s_sleep 2
    s_sub_u32 s9, s9, 1
    s_and_b32 s100, s9, 127
    s_cbranch_scc1 L_pf2
    s_lshl_b32 s100, s6, 7
    s_load_dwordx2 s[100:101], s[34:35], s100 glc
    s_waitcnt lgkmcnt(0)
    s_cmp_eq_u64 s[100:101], 0
    s_cbranch_scc1 L_pf2_nz
    s_not_b64 s[96:97], s[100:101]
L_pf2_nz:
    s_cmp_lg_u32 s9, 0
    s_cbranch_scc1 L_pf2
L_pf2_ok:
    s_mov_b64 exec, -1
    buffer_load_dwordx4 v[80:83], v9, s[52:55], s39 offen offset:0 sc1
    buffer_load_dwordx4 v[84:87], v9, s[52:55], s39 offen offset:1024 sc1
    buffer_load_dwordx4 v[88:91], v9, s[52:55], s39 offen offset:2048 sc1
    buffer_load_dwordx4 v[92:95], v9, s[52:55], s39 offen offset:3072 sc1
    buffer_load_dwordx4 v[96:99], v9, s[52:55], s43 offen offset:0 sc1
    buffer_load_dwordx4 v[100:103], v9, s[52:55], s43 offen offset:1024 sc1
    s_waitcnt vmcnt(4)
    v_lshlrev_b32 v250, 16, v80
    v_and_b32 v251, 0xffff0000, v80
    v_add_f32 v16, v16, v250
    v_add_f32 v17, v17, v251
    v_lshlrev_b32 v250, 16, v81
    v_and_b32 v251, 0xffff0000, v81
    v_add_f32 v18, v18, v250
    v_add_f32 v19, v19, v251
    v_lshlrev_b32 v250, 16, v82
    v_and_b32 v251, 0xffff0000, v82
    v_add_f32 v20, v20, v250
    v_add_f32 v21, v21, v251
    v_lshlrev_b32 v250, 16, v83
    v_and_b32 v251, 0xffff0000, v83
    v_add_f32 v22, v22, v250
    v_add_f32 v23, v23, v251
    v_lshlrev_b32 v250, 16, v84
    v_and_b32 v251, 0xffff0000, v84
    v_add_f32 v24, v24, v250
    v_add_f32 v25, v25, v251
    v_lshlrev_b32 v250, 16, v85
    v_and_b32 v251, 0xffff0000, v85
    v_add_f32 v26, v26, v250
    v_add_f32 v27, v27, v251
    v_lshlrev_b32 v250, 16, v86
    v_and_b32 v251, 0xffff0000, v86
    v_add_f32 v28, v28, v250
    v_add_f32 v29, v29, v251
    v_lshlrev_b32 v250, 16, v87
    v_and_b32 v251, 0xffff0000, v87
    v_add_f32 v30, v30, v250
    v_add_f32 v31, v31, v251
    s_waitcnt vmcnt(2)
    v_lshlrev_b32 v250, 16, v88
    v_and_b32 v251, 0xffff0000, v88
    v_add_f32 v16, v16, v250
    v_add_f32 v17, v17, v251
    v_lshlrev_b32 v250, 16, v89
    v_and_b32 v251, 0xffff0000, v89
    v_add_f32 v18, v18, v250
    v_add_f32 v19, v19, v251
    v_lshlrev_b32 v250, 16, v90
    v_and_b32 v251, 0xffff0000, v90
    v_add_f32 v20, v20, v250
    v_add_f32 v21, v21, v251
    v_lshlrev_b32 v250, 16, v91
    v_and_b32 v251, 0xffff0000, v91
    v_add_f32 v22, v22, v250
    v_add_f32 v23, v23, v251
    v_lshlrev_b32 v250, 16, v92
    v_and_b32 v251, 0xffff0000, v92
    v_add_f32 v24, v24, v250
    v_add_f32 v25, v25, v251
    v_lshlrev_b32 v250, 16, v93
    v_and_b32 v251, 0xffff0000, v93
    v_add_f32 v26, v26, v250
    v_add_f32 v27, v27, v251
    v_lshlrev_b32 v250, 16, v94
    v_and_b32 v251, 0xffff0000, v94
    v_add_f32 v28, v28, v250
    v_add_f32 v29, v29, v251
    v_lshlrev_b32 v250, 16, v95
    v_and_b32 v251, 0xffff0000, v95
    v_add_f32 v30, v30, v250
    v_add_f32 v31, v31, v251
    s_waitcnt vmcnt(0)
    v_lshlrev_b32 v250, 16, v96
    v_and_b32 v251, 0xffff0000, v96
    v_add_f32 v16, v16, v250
    v_add_f32 v17, v17, v251
    v_lshlrev_b32 v250, 16, v97
    v_and_b32 v251, 0xffff0000, v97
    v_add_f32 v18, v18, v250
    v_add_f32 v19, v19, v251
    v_lshlrev_b32 v250, 16, v98
    v_and_b32 v251, 0xffff0000, v98
    v_add_f32 v20, v20, v250
    v_add_f32 v21, v21, v251
    v_lshlrev_b32 v250, 16, v99
    v_and_b32 v251, 0xffff0000, v99
    v_add_f32 v22, v22, v250
    v_add_f32 v23, v23, v251
    v_lshlrev_b32 v250, 16, v100
    v_and_b32 v251, 0xffff0000, v100
    v_add_f32 v24, v24, v250
    v_add_f32 v25, v25, v251
    v_lshlrev_b32 v250, 16, v101
    v_and_b32 v251, 0xffff0000, v101
    v_add_f32 v26, v26, v250
    v_add_f32 v27, v27, v251
    v_lshlrev_b32 v250, 16, v102
    v_and_b32 v251, 0xffff0000, v102
    v_add_f32 v28, v28, v250
    v_add_f32 v29, v29, v251
    v_lshlrev_b32 v250, 16, v103
    v_and_b32 v251, 0xffff0000, v103
    v_add_f32 v30, v30, v250
    v_add_f32 v31, v31, v251
    v_cvt_pk_bf16_f32 v16, v16, v17
    v_cvt_pk_bf16_f32 v17, v18, v19
    buffer_store_dwordx2 v[16:17], v7, s[44:47], s41 offen offset:0
    v_cvt_pk_bf16_f32 v20, v20, v21
    v_cvt_pk_bf16_f32 v21, v22, v23
    buffer_store_dwordx2 v[20:21], v7, s[44:47], s41 offen offset:32
    v_cvt_pk_bf16_f32 v24, v24, v25
    v_cvt_pk_bf16_f32 v25, v26, v27
    buffer_store_dwordx2 v[24:25], v7, s[44:47], s41 offen offset:64
    v_cvt_pk_bf16_f32 v28, v28, v29
    v_cvt_pk_bf16_f32 v29, v30, v31
    buffer_store_dwordx2 v[28:29], v7, s[44:47], s41 offen offset:96
L_cdone:
L_end:
    s_endpgm
.section .rodata,"a"
.p2align 6
.amdhsa_kernel concat_heads__gqa_block_cached__gqa_block_cached__near_ridge_kernel
  .amdhsa_next_free_vgpr 256
  .amdhsa_next_free_sgpr 102
  .amdhsa_accum_offset 256
  .amdhsa_group_segment_fixed_size 0
  .amdhsa_kernarg_size 104
  .amdhsa_user_sgpr_count 2
  .amdhsa_user_sgpr_kernarg_segment_ptr 1
  .amdhsa_system_sgpr_workgroup_id_x 1
.end_amdhsa_kernel
```
